```python
import torch

def _softmax(x, axis=-1):
    return torch.softmax(x, dim=axis)
def _gelu(x):
    return torch.nn.functional.gelu(x, approximate="tanh")
def _silu(x):
    return torch.nn.functional.silu(x)
def _sigmoid(x):
    return torch.sigmoid(x)
def _layernorm(x, axis=-1, eps=1e-5):
    m = x.mean(dim=axis, keepdim=True)
    v = x.var(dim=axis, keepdim=True, unbiased=False)
    return (x - m) / torch.sqrt(v + eps)
def _scatter_add(tgt, idx, src, axis=0):
    return tgt.clone().index_add_(axis, idx, src)
def _segment_sum(src, seg, n):
    out = torch.zeros((n,) + src.shape[1:], dtype=src.dtype)
    return out.index_add_(0, seg, src)
def _pad(x, pw):
    flat = tuple(v for pair in reversed(pw) for v in pair)
    return torch.nn.functional.pad(x, flat)

kernel_name = 'standalone__gqa_softmax__prompt'

def setup_inputs():

    _w = (lambda a: (lambda t: t.to(torch.bfloat16) if t.is_floating_point() else t)(torch.as_tensor(a)))
    B, Hq, Hkv, Sq, Sk, D = 1, 32, 8, 2048, 2048, 128
    return {
        "q": _w((lambda *s: torch.randn(*s, dtype=torch.bfloat16) * 0.8)(B, Hq, Sq, D)),
        "k": _w((lambda *s: torch.randn(*s, dtype=torch.bfloat16) * 0.8)(B, Hkv, Sk, D)),
        "v": _w((lambda *s: torch.randn(*s, dtype=torch.bfloat16) * 0.05)(B, Hkv, Sk, D)),
    }

def reference(q, k, v):
    B, Hq, Sq, D = q.shape
    Hkv = k.shape[1]
    rep = Hq // Hkv
    k = (lambda x, n, axis: torch.repeat_interleave(x, n, dim=axis))(k, rep, axis=1)
    v = (lambda x, n, axis: torch.repeat_interleave(x, n, dim=axis))(v, rep, axis=1)
    scale = D ** -0.5
    scores = torch.einsum("bhqd,bhkd->bhqk", q, k) * scale
    p = _softmax(scores, axis=-1)
    return torch.einsum("bhqk,bhkd->bhqd", p, v)
```

```asm
; @launch grid=(256,1,1) block=(256,1,1) lds=163840
.amdgcn_target "amdgcn-amd-amdhsa--gfx950"
.text
.globl standalone__gqa_softmax__prompt_kernel
.p2align 8
.type standalone__gqa_softmax__prompt_kernel,@function
standalone__gqa_softmax__prompt_kernel:
    s_cmp_ge_u32 s2, 256
    s_cbranch_scc1 L_end
    s_load_dwordx4 s[4:7], s[0:1], 0
    s_load_dwordx4 s[24:27], s[0:1], 16
s_getpc_b64 s[52:53]
L_pc:
    s_lshr_b32 s50, s2, 3
    s_and_b32 s50, s50, 7
    s_lshl_b32 s50, s50, 12
    v_lshl_add_u32 v11, v0, 4, s50
    v_min_u32 v11, (L_end - L_pc - 16), v11
    global_load_dwordx4 v[236:239], v11, s[52:53]
    v_lshrrev_b32 v2, 6, v0
    v_and_b32 v1, 63, v0
    v_readfirstlane_b32 s28, v2
    v_lshrrev_b32 v3, 4, v1
    v_and_b32 v4, 15, v1
    s_and_b32 s50, s2, 7
    s_lshr_b32 s51, s2, 3
    s_lshl_b32 s29, s28, 12
    v_lshlrev_b32 v5, 1, v3
    v_xor_b32 v5, v5, v4
    v_lshlrev_b32 v6, 8, v3
    v_lshl_add_u32 v8, v5, 4, v6
    v_add_u32 v12, s29, v8
    v_xor_b32 v13, 0x80, v12
    s_lshl_b32 s52, s50, 21
    s_lshl_b32 s53, s51, 16
    s_add_u32 s52, s52, s53
    s_lshl_b32 s53, s28, 14
    s_add_u32 s36, s52, s53
    s_sub_u32 s41, s36, s29
    s_add_u32 s42, s53, 0x18000
    s_add_u32 s96, s29, 0
    s_add_u32 s97, s29, 16384
    s_add_u32 s98, s29, 32768
    s_add_u32 s99, s29, 49152
    s_add_u32 s100, s29, 65536
    s_add_u32 s101, s29, 81920
    s_lshl_b32 s50, s50, 19
    s_mov_b32 s32, 0
    s_mov_b64 s[48:49], -1
    s_mov_b32 s14, 0x80000
    s_mov_b32 s15, 0x20000
    s_mov_b32 s10, 0x1000000
    s_mov_b32 s11, 0x20000
    s_mov_b32 s18, 0x80000
    s_mov_b32 s19, 0x20000
    s_mov_b32 s22, 0x1000000
    s_mov_b32 s23, 0x20000
    s_waitcnt lgkmcnt(0)
    s_add_u32 s12, s6, s50
    s_addc_u32 s13, s7, 0
    s_mov_b32 s8, s4
    s_mov_b32 s9, s5
    s_add_u32 s16, s24, s50
    s_addc_u32 s17, s25, 0
L_restart:
    s_mov_b32 m0, s96
    s_mov_b32 s33, 0
    buffer_load_dwordx4 v12, s[12:15], s33 offen lds
    buffer_load_dwordx4 v13, s[12:15], s33 offen offset:1024 lds
    buffer_load_dwordx4 v12, s[12:15], s33 offen offset:2048 lds
    buffer_load_dwordx4 v13, s[12:15], s33 offen offset:3072 lds
    s_add_u32 m0, s42, 0
    s_add_u32 s33, s41, 0
    buffer_load_dwordx4 v12, s[8:11], s33 offen nt lds
    buffer_load_dwordx4 v13, s[8:11], s33 offen offset:1024 nt lds
    buffer_load_dwordx4 v12, s[8:11], s33 offen offset:2048 nt lds
    buffer_load_dwordx4 v13, s[8:11], s33 offen offset:3072 nt lds
    s_mov_b32 m0, s99
    s_mov_b32 s33, 0
    buffer_load_dwordx4 v12, s[16:19], s33 offen lds
    buffer_load_dwordx4 v13, s[16:19], s33 offen offset:1024 lds
    buffer_load_dwordx4 v12, s[16:19], s33 offen offset:2048 lds
    buffer_load_dwordx4 v13, s[16:19], s33 offen offset:3072 lds
    s_mov_b32 s20, s26
    s_mov_b32 s21, s27
    s_add_u32 s37, s36, 4096
    s_add_u32 s38, s37, 4096
    s_add_u32 s39, s38, 4096
    v_lshrrev_b32 v3, 4, v1
    v_and_b32 v4, 15, v1
    v_subrev_u32 v8, s29, v12
    v_add_u32 v212, s42, v8
    v_xor_b32 v213, 16, v212
    v_and_b32 v5, 7, v1
    v_lshlrev_b32 v5, 1, v5
    v_xor_b32 v5, v5, v3
    v_lshlrev_b32 v7, 8, v4
    v_lshl_add_u32 v16, v5, 4, v7
    v_xor_b32 v17, 64, v16
    v_xor_b32 v18, 128, v16
    v_xor_b32 v19, 192, v16
    v_add_u32 v28, s42, v16
    v_add_u32 v29, s42, v17
    v_add_u32 v30, s42, v18
    v_add_u32 v31, s42, v19
    v_lshrrev_b32 v8, 2, v1
    v_and_b32 v9, 7, v8
    v_lshlrev_b32 v9, 5, v9
    v_and_b32 v10, 3, v1
    v_lshl_add_u32 v9, v10, 3, v9
    v_lshlrev_b32 v8, 8, v8
    v_add_u32 v8, 0xc000, v8
    v_add_u32 v20, v8, v9
    v_xor_b32 v21, 32, v20
    v_xor_b32 v22, 64, v20
    v_xor_b32 v23, 96, v20
    v_xor_b32 v24, 128, v20
    v_xor_b32 v25, 160, v20
    v_xor_b32 v26, 192, v20
    v_xor_b32 v27, 224, v20
    v_bfe_u32 v6, v1, 2, 2
    v_xor_b32 v5, v6, v3
    v_lshlrev_b32 v5, 3, v5
    v_lshl_add_u32 v5, v4, 5, v5
    v_add_u32 v208, s42, v5
    v_xor_b32 v209, 8, v208
    v_xor_b32 v210, 16, v208
    v_xor_b32 v211, 24, v208
    v_lshrrev_b32 v8, 5, v1
    v_xor_b32 v5, v8, v10
    v_lshlrev_b32 v5, 3, v5
    v_lshl_add_u32 v5, v6, 5, v5
    v_lshl_add_u32 v5, v10, 9, v5
    v_bfe_u32 v9, v1, 4, 1
    v_lshl_add_u32 v5, v9, 11, v5
    v_bfe_u32 v9, v1, 1, 1
    v_lshl_or_b32 v8, v8, 1, v9
    v_bfe_u32 v9, v1, 2, 3
    v_lshlrev_b32 v9, 5, v9
    v_lshl_add_u32 v8, v8, 9, v9
    v_and_b32 v9, 1, v1
    v_lshl_add_u32 v14, v9, 4, v8
    s_mov_b32 s94, 0x55555555
    s_mov_b32 s95, 0x55555555
    v_add_u32 v212, s42, v5
    v_xor_b32 v213, 8, v212
    v_xor_b32 v252, 16, v212
    v_xor_b32 v253, 24, v212
    v_cmp_gt_u32 vcc, 2, v10
    v_mov_b32 v11, 0x3f803f80
    v_and_b32 v5, 1, v1
    v_mul_u32_u24 v5, 0xaaaa, v5
    v_add_u32 v15, 0x4444, v5
    v_cndmask_b32 v216, 0, v11, vcc
    v_cndmask_b32 v217, 0, v11, vcc
    v_cndmask_b32 v218, 0, v11, vcc
    v_cndmask_b32 v219, 0, v11, vcc
    v_mov_b32 v220, 0
    v_mov_b32 v221, 0
    v_mov_b32 v222, 0
    v_mov_b32 v223, 0
    v_mov_b32 v224, 0
    v_mov_b32 v225, 0
    v_mov_b32 v226, 0
    v_mov_b32 v227, 0
    v_mov_b32 v228, 0
    v_mov_b32 v229, 0
    v_mov_b32 v230, 0
    v_mov_b32 v231, 0
    v_mov_b32 v232, 0
    v_mov_b32 v233, 0
    v_mov_b32 v234, 0
    v_mov_b32 v235, 0
    s_mov_b32 s34, 0x3e0293ee
    s_mov_b32 s35, 0x3e0293ee
    s_mov_b32 s40, 0x5b800000
    s_mov_b32 s43, 0xffff0000
    s_mov_b64 s[44:45], 0
    v_cndmask_b32 v32, v32, 0, s[48:49]
    v_cndmask_b32 v33, v33, 0, s[48:49]
    v_cndmask_b32 v34, v34, 0, s[48:49]
    v_cndmask_b32 v35, v35, 0, s[48:49]
    v_cndmask_b32 v36, v36, 0, s[48:49]
    v_cndmask_b32 v37, v37, 0, s[48:49]
    v_cndmask_b32 v38, v38, 0, s[48:49]
    v_cndmask_b32 v39, v39, 0, s[48:49]
    v_cndmask_b32 v40, v40, 0, s[48:49]
    v_cndmask_b32 v41, v41, 0, s[48:49]
    v_cndmask_b32 v42, v42, 0, s[48:49]
    v_cndmask_b32 v43, v43, 0, s[48:49]
    v_cndmask_b32 v44, v44, 0, s[48:49]
    v_cndmask_b32 v45, v45, 0, s[48:49]
    v_cndmask_b32 v46, v46, 0, s[48:49]
    v_cndmask_b32 v47, v47, 0, s[48:49]
    s_add_u32 m0, s42, 4096
    s_add_u32 s33, s41, 4096
    buffer_load_dwordx4 v12, s[8:11], s33 offen nt lds
    buffer_load_dwordx4 v13, s[8:11], s33 offen offset:1024 nt lds
    buffer_load_dwordx4 v12, s[8:11], s33 offen offset:2048 nt lds
    buffer_load_dwordx4 v13, s[8:11], s33 offen offset:3072 nt lds
    s_waitcnt vmcnt(8)
    ds_read_b128 v[144:147], v28 offset:0
    ds_read_b128 v[148:151], v29 offset:0
    ds_read_b128 v[152:155], v30 offset:0
    ds_read_b128 v[156:159], v31 offset:0
    s_barrier
    ds_read_b128 a[128:131], v16 offset:0
    ds_read_b128 a[132:135], v17 offset:0
    ds_read_b128 a[136:139], v18 offset:0
    ds_read_b128 a[140:143], v19 offset:0
    ds_read_b128 a[156:159], v19 offset:4096
    ds_read_b128 a[152:155], v18 offset:4096
    ds_read_b128 a[148:151], v17 offset:4096
    ds_read_b128 a[144:147], v16 offset:4096
    ds_read_b128 a[160:163], v16 offset:8192
    ds_read_b128 a[164:167], v17 offset:8192
    ds_read_b128 a[168:171], v18 offset:8192
    ds_read_b128 a[172:175], v19 offset:8192
    ds_read_b128 a[188:191], v19 offset:12288
    ds_read_b128 a[184:187], v18 offset:12288
    ds_read_b128 a[180:183], v17 offset:12288
    ds_read_b128 a[176:179], v16 offset:12288
    s_add_u32 m0, s42, 8192
    s_add_u32 s33, s41, 8192
    buffer_load_dwordx4 v12, s[8:11], s33 offen nt lds
    buffer_load_dwordx4 v13, s[8:11], s33 offen offset:1024 nt lds
    buffer_load_dwordx4 v12, s[8:11], s33 offen offset:2048 nt lds
    buffer_load_dwordx4 v13, s[8:11], s33 offen offset:3072 nt lds
    s_waitcnt lgkmcnt(14)
    v_lshlrev_b32 v236, 16, v144
    v_and_b32 v237, s43, v144
    v_lshlrev_b32 v238, 16, v145
    v_and_b32 v239, s43, v145
    v_lshlrev_b32 v240, 16, v146
    v_and_b32 v241, s43, v146
    v_lshlrev_b32 v242, 16, v147
    v_and_b32 v243, s43, v147
    v_pk_mul_f32 v[236:237], v[236:237], s[34:35]
    v_pk_mul_f32 v[238:239], v[238:239], s[34:35]
    v_pk_mul_f32 v[240:241], v[240:241], s[34:35]
    v_pk_mul_f32 v[242:243], v[242:243], s[34:35]
    v_cvt_pk_bf16_f32 v144, v236, v237
    v_cvt_pk_bf16_f32 v145, v238, v239
    v_cvt_pk_bf16_f32 v146, v240, v241
    v_cvt_pk_bf16_f32 v147, v242, v243
    v_lshlrev_b32 v244, 16, v148
    v_and_b32 v245, s43, v148
    v_lshlrev_b32 v246, 16, v149
    v_and_b32 v247, s43, v149
    v_lshlrev_b32 v248, 16, v150
    v_and_b32 v249, s43, v150
    v_lshlrev_b32 v250, 16, v151
    v_and_b32 v251, s43, v151
    v_pk_mul_f32 v[244:245], v[244:245], s[34:35]
    v_pk_mul_f32 v[246:247], v[246:247], s[34:35]
    v_pk_mul_f32 v[248:249], v[248:249], s[34:35]
    v_pk_mul_f32 v[250:251], v[250:251], s[34:35]
    v_cvt_pk_bf16_f32 v148, v244, v245
    v_cvt_pk_bf16_f32 v149, v246, v247
    v_cvt_pk_bf16_f32 v150, v248, v249
    v_cvt_pk_bf16_f32 v151, v250, v251
    v_lshlrev_b32 v236, 16, v152
    v_and_b32 v237, s43, v152
    v_lshlrev_b32 v238, 16, v153
    v_and_b32 v239, s43, v153
    v_lshlrev_b32 v240, 16, v154
    v_and_b32 v241, s43, v154
    v_lshlrev_b32 v242, 16, v155
    v_and_b32 v243, s43, v155
    v_pk_mul_f32 v[236:237], v[236:237], s[34:35]
    v_pk_mul_f32 v[238:239], v[238:239], s[34:35]
    v_pk_mul_f32 v[240:241], v[240:241], s[34:35]
    v_pk_mul_f32 v[242:243], v[242:243], s[34:35]
    v_cvt_pk_bf16_f32 v152, v236, v237
    v_cvt_pk_bf16_f32 v153, v238, v239
    v_cvt_pk_bf16_f32 v154, v240, v241
    v_cvt_pk_bf16_f32 v155, v242, v243
    v_lshlrev_b32 v244, 16, v156
    v_and_b32 v245, s43, v156
    v_lshlrev_b32 v246, 16, v157
    v_and_b32 v247, s43, v157
    v_lshlrev_b32 v248, 16, v158
    v_and_b32 v249, s43, v158
    v_lshlrev_b32 v250, 16, v159
    v_and_b32 v251, s43, v159
    v_pk_mul_f32 v[244:245], v[244:245], s[34:35]
    v_pk_mul_f32 v[246:247], v[246:247], s[34:35]
    v_pk_mul_f32 v[248:249], v[248:249], s[34:35]
    v_pk_mul_f32 v[250:251], v[250:251], s[34:35]
    v_cvt_pk_bf16_f32 v156, v244, v245
    v_cvt_pk_bf16_f32 v157, v246, v247
    v_cvt_pk_bf16_f32 v158, v248, v249
    v_cvt_pk_bf16_f32 v159, v250, v251
    s_waitcnt lgkmcnt(0)
    v_mfma_f32_16x16x32_bf16 v[80:83], a[128:131], v[144:147], v[32:35]
    v_mfma_f32_16x16x32_bf16 v[80:83], a[132:135], v[148:151], v[80:83]
    v_mfma_f32_16x16x32_bf16 v[80:83], a[136:139], v[152:155], v[80:83]
    v_mfma_f32_16x16x32_bf16 v[80:83], a[140:143], v[156:159], v[80:83]
    s_nop 4
    s_nop 0
    s_nop 0
    s_nop 0
    v_max3_f32 v2, v80, v81, v82
    v_max_f32 v2, v2, v83
    v_mov_b32 v4, v2
    s_nop 0
    s_nop 0
    v_permlane32_swap_b32 v2, v4
    v_max_f32 v2, v2, v4
    v_mov_b32 v4, v2
    s_nop 0
    s_nop 0
    v_permlane16_swap_b32 v2, v4
    v_max_f32 v2, v2, v4
    v_add_f32 v2, 0x420c0000, v2
    v_cndmask_b32 v2, 0, v2, s[48:49]
    v_sub_f32 v32, v32, v2
    v_sub_f32 v33, v33, v2
    v_sub_f32 v34, v34, v2
    v_sub_f32 v35, v35, v2
    v_sub_f32 v80, v80, v2
    v_sub_f32 v81, v81, v2
    v_sub_f32 v82, v82, v2
    v_sub_f32 v83, v83, v2
    s_waitcnt vmcnt(8)
    s_barrier
    v_mfma_f32_16x16x32_bf16 v[84:87], a[156:159], v[156:159], v[32:35]
    ds_read_b64_tr_b16 a[192:193], v20 offset:0
    ds_read_b64_tr_b16 a[194:195], v20 offset:4096
    ds_read_b64_tr_b16 a[196:197], v20 offset:8192
    ds_read_b64_tr_b16 a[198:199], v20 offset:12288
    v_exp_f32 v80, v80
    v_mfma_f32_16x16x32_bf16 v[84:87], a[152:155], v[152:155], v[84:87]
    ds_read_b64_tr_b16 a[200:201], v21 offset:0
    ds_read_b64_tr_b16 a[202:203], v21 offset:4096
    ds_read_b64_tr_b16 a[204:205], v21 offset:8192
    ds_read_b64_tr_b16 a[206:207], v21 offset:12288
    v_exp_f32 v81, v81
    v_mfma_f32_16x16x32_bf16 v[84:87], a[148:151], v[148:151], v[84:87]
    ds_read_b64_tr_b16 a[208:209], v22 offset:0
    ds_read_b64_tr_b16 a[210:211], v22 offset:4096
    ds_read_b64_tr_b16 a[212:213], v22 offset:8192
    ds_read_b64_tr_b16 a[214:215], v22 offset:12288
    v_exp_f32 v82, v82
    v_mfma_f32_16x16x32_bf16 v[84:87], a[144:147], v[144:147], v[84:87]
    ds_read_b64_tr_b16 a[216:217], v23 offset:0
    ds_read_b64_tr_b16 a[218:219], v23 offset:4096
    ds_read_b64_tr_b16 a[220:221], v23 offset:8192
    ds_read_b64_tr_b16 a[222:223], v23 offset:12288
    v_exp_f32 v83, v83
    v_mfma_f32_16x16x32_bf16 v[88:91], a[160:163], v[144:147], v[32:35]
    ds_read_b64_tr_b16 a[224:225], v24 offset:0
    ds_read_b64_tr_b16 a[226:227], v24 offset:4096
    ds_read_b64_tr_b16 a[228:229], v24 offset:8192
    ds_read_b64_tr_b16 a[230:231], v24 offset:12288
    v_cvt_pk_bf16_f32 v48, v80, v81
    v_mfma_f32_16x16x32_bf16 v[88:91], a[164:167], v[148:151], v[88:91]
    ds_read_b64_tr_b16 a[232:233], v25 offset:0
    ds_read_b64_tr_b16 a[234:235], v25 offset:4096
    ds_read_b64_tr_b16 a[236:237], v25 offset:8192
    ds_read_b64_tr_b16 a[238:239], v25 offset:12288
    v_mfma_f32_16x16x32_bf16 v[88:91], a[168:171], v[152:155], v[88:91]
    ds_read_b64_tr_b16 a[240:241], v26 offset:0
    ds_read_b64_tr_b16 a[242:243], v26 offset:4096
    ds_read_b64_tr_b16 a[244:245], v26 offset:8192
    ds_read_b64_tr_b16 a[246:247], v26 offset:12288
    v_exp_f32 v84, v84
    v_mfma_f32_16x16x32_bf16 v[88:91], a[172:175], v[156:159], v[88:91]
    ds_read_b64_tr_b16 a[248:249], v27 offset:0
    ds_read_b64_tr_b16 a[250:251], v27 offset:4096
    ds_read_b64_tr_b16 a[252:253], v27 offset:8192
    ds_read_b64_tr_b16 a[254:255], v27 offset:12288
    v_exp_f32 v85, v85
    v_mfma_f32_16x16x32_bf16 v[92:95], a[188:191], v[156:159], v[32:35]
    s_add_u32 m0, s42, 12288
    s_add_u32 s33, s41, 12288
    v_cvt_pk_bf16_f32 v49, v82, v83
    v_exp_f32 v86, v86
    v_mfma_f32_16x16x32_bf16 v[92:95], a[184:187], v[152:155], v[92:95]
    buffer_load_dwordx4 v12, s[8:11], s33 offen nt lds
    v_exp_f32 v87, v87
    v_cvt_pk_bf16_f32 v50, v84, v85
    v_mfma_f32_16x16x32_bf16 v[92:95], a[180:183], v[148:151], v[92:95]
    buffer_load_dwordx4 v13, s[8:11], s33 offen offset:1024 nt lds
    v_exp_f32 v88, v88
    v_exp_f32 v89, v89
    v_cvt_pk_bf16_f32 v51, v86, v87
    v_mfma_f32_16x16x32_bf16 v[92:95], a[176:179], v[144:147], v[92:95]
    buffer_load_dwordx4 v12, s[8:11], s33 offen offset:2048 nt lds
    buffer_load_dwordx4 v13, s[8:11], s33 offen offset:3072 nt lds
    v_exp_f32 v90, v90
    v_exp_f32 v91, v91
    v_cvt_pk_bf16_f32 v52, v88, v89
    s_nop 2
    v_exp_f32 v92, v92
    v_exp_f32 v93, v93
    v_cvt_pk_bf16_f32 v53, v90, v91
    v_exp_f32 v94, v94
    v_exp_f32 v95, v95
    v_cvt_pk_bf16_f32 v54, v92, v93
    v_cvt_pk_bf16_f32 v55, v94, v95
    s_waitcnt vmcnt(8)
    ds_read_b128 v[160:163], v28 offset:4096
    ds_read_b128 v[164:167], v29 offset:4096
    ds_read_b128 v[168:171], v30 offset:4096
    ds_read_b128 v[172:175], v31 offset:4096
    s_mov_b32 m0, s97
    s_mov_b32 s33, 16384
    buffer_load_dwordx4 v12, s[12:15], s33 offen lds
    buffer_load_dwordx4 v13, s[12:15], s33 offen offset:1024 lds
    buffer_load_dwordx4 v12, s[12:15], s33 offen offset:2048 lds
    buffer_load_dwordx4 v13, s[12:15], s33 offen offset:3072 lds
    s_waitcnt lgkmcnt(0)
    v_lshlrev_b32 v236, 16, v160
    v_and_b32 v237, s43, v160
    v_lshlrev_b32 v238, 16, v161
    v_and_b32 v239, s43, v161
    v_lshlrev_b32 v240, 16, v162
    v_and_b32 v241, s43, v162
    v_lshlrev_b32 v242, 16, v163
    v_and_b32 v243, s43, v163
    v_pk_mul_f32 v[236:237], v[236:237], s[34:35]
    v_pk_mul_f32 v[238:239], v[238:239], s[34:35]
    v_pk_mul_f32 v[240:241], v[240:241], s[34:35]
    v_pk_mul_f32 v[242:243], v[242:243], s[34:35]
    v_cvt_pk_bf16_f32 v160, v236, v237
    v_cvt_pk_bf16_f32 v161, v238, v239
    v_cvt_pk_bf16_f32 v162, v240, v241
    v_cvt_pk_bf16_f32 v163, v242, v243
    v_lshlrev_b32 v244, 16, v164
    v_and_b32 v245, s43, v164
    v_lshlrev_b32 v246, 16, v165
    v_and_b32 v247, s43, v165
    v_lshlrev_b32 v248, 16, v166
    v_and_b32 v249, s43, v166
    v_lshlrev_b32 v250, 16, v167
    v_and_b32 v251, s43, v167
    v_pk_mul_f32 v[244:245], v[244:245], s[34:35]
    v_pk_mul_f32 v[246:247], v[246:247], s[34:35]
    v_pk_mul_f32 v[248:249], v[248:249], s[34:35]
    v_pk_mul_f32 v[250:251], v[250:251], s[34:35]
    v_cvt_pk_bf16_f32 v164, v244, v245
    v_cvt_pk_bf16_f32 v165, v246, v247
    v_cvt_pk_bf16_f32 v166, v248, v249
    v_cvt_pk_bf16_f32 v167, v250, v251
    v_lshlrev_b32 v236, 16, v168
    v_and_b32 v237, s43, v168
    v_lshlrev_b32 v238, 16, v169
    v_and_b32 v239, s43, v169
    v_lshlrev_b32 v240, 16, v170
    v_and_b32 v241, s43, v170
    v_lshlrev_b32 v242, 16, v171
    v_and_b32 v243, s43, v171
    v_pk_mul_f32 v[236:237], v[236:237], s[34:35]
    v_pk_mul_f32 v[238:239], v[238:239], s[34:35]
    v_pk_mul_f32 v[240:241], v[240:241], s[34:35]
    v_pk_mul_f32 v[242:243], v[242:243], s[34:35]
    v_cvt_pk_bf16_f32 v168, v236, v237
    v_cvt_pk_bf16_f32 v169, v238, v239
    v_cvt_pk_bf16_f32 v170, v240, v241
    v_cvt_pk_bf16_f32 v171, v242, v243
    v_lshlrev_b32 v244, 16, v172
    v_and_b32 v245, s43, v172
    v_lshlrev_b32 v246, 16, v173
    v_and_b32 v247, s43, v173
    v_lshlrev_b32 v248, 16, v174
    v_and_b32 v249, s43, v174
    v_lshlrev_b32 v250, 16, v175
    v_and_b32 v251, s43, v175
    v_pk_mul_f32 v[244:245], v[244:245], s[34:35]
    v_pk_mul_f32 v[246:247], v[246:247], s[34:35]
    v_pk_mul_f32 v[248:249], v[248:249], s[34:35]
    v_pk_mul_f32 v[250:251], v[250:251], s[34:35]
    v_cvt_pk_bf16_f32 v172, v244, v245
    v_cvt_pk_bf16_f32 v173, v246, v247
    v_cvt_pk_bf16_f32 v174, v248, v249
    v_cvt_pk_bf16_f32 v175, v250, v251
    s_waitcnt lgkmcnt(0)
    v_mfma_f32_16x16x32_bf16 v[108:111], a[176:179], v[160:163], v[36:39]
    v_mfma_f32_16x16x32_bf16 v[108:111], a[180:183], v[164:167], v[108:111]
    v_mfma_f32_16x16x32_bf16 v[108:111], a[184:187], v[168:171], v[108:111]
    v_mfma_f32_16x16x32_bf16 v[108:111], a[188:191], v[172:175], v[108:111]
    v_mfma_f32_16x16x32_bf16 a[0:3], v[48:51], a[192:195], 0
    v_mfma_f32_16x16x32_bf16 a[0:3], v[52:55], a[196:199], a[0:3]
    s_nop 2
    s_nop 0
    s_nop 0
    s_nop 0
    v_max3_f32 v2, v108, v109, v110
    v_max_f32 v2, v2, v111
    v_mov_b32 v4, v2
    v_mfma_f32_16x16x32_bf16 a[4:7], v[52:55], a[204:207], 0
    s_nop 0
    v_permlane32_swap_b32 v2, v4
    v_max_f32 v2, v2, v4
    v_mov_b32 v4, v2
    v_mfma_f32_16x16x32_bf16 a[4:7], v[48:51], a[200:203], a[4:7]
    s_nop 0
    v_permlane16_swap_b32 v2, v4
    v_max_f32 v2, v2, v4
    v_add_f32 v2, 0x420c0000, v2
    v_mfma_f32_16x16x32_bf16 a[8:11], v[48:51], a[208:211], 0
    v_cndmask_b32 v2, 0, v2, s[48:49]
    v_sub_f32 v36, v36, v2
    v_sub_f32 v37, v37, v2
    v_mfma_f32_16x16x32_bf16 a[8:11], v[52:55], a[212:215], a[8:11]
    v_sub_f32 v38, v38, v2
    v_sub_f32 v39, v39, v2
    v_mfma_f32_16x16x32_bf16 a[12:15], v[52:55], a[220:223], 0
    v_sub_f32 v108, v108, v2
    v_sub_f32 v109, v109, v2
    v_mfma_f32_16x16x32_bf16 a[12:15], v[48:51], a[216:219], a[12:15]
    v_sub_f32 v110, v110, v2
    v_sub_f32 v111, v111, v2
    v_mfma_f32_16x16x32_bf16 v[104:107], a[172:175], v[172:175], v[36:39]
    v_exp_f32 v108, v108
    v_mfma_f32_16x16x32_bf16 v[104:107], a[168:171], v[168:171], v[104:107]
    v_exp_f32 v109, v109
    v_mfma_f32_16x16x32_bf16 v[104:107], a[164:167], v[164:167], v[104:107]
    v_exp_f32 v110, v110
    v_mfma_f32_16x16x32_bf16 v[104:107], a[160:163], v[160:163], v[104:107]
    v_exp_f32 v111, v111
    v_cvt_pk_bf16_f32 v62, v108, v109
    v_mfma_f32_16x16x32_bf16 v[100:103], a[144:147], v[160:163], v[36:39]
    v_mfma_f32_16x16x32_bf16 v[100:103], a[148:151], v[164:167], v[100:103]
    v_mfma_f32_16x16x32_bf16 v[100:103], a[152:155], v[168:171], v[100:103]
    s_nop 0
    s_nop 1
    v_exp_f32 v104, v104
    v_mfma_f32_16x16x32_bf16 v[100:103], a[156:159], v[172:175], v[100:103]
    v_exp_f32 v105, v105
    v_cvt_pk_bf16_f32 v63, v110, v111
    v_mfma_f32_16x16x32_bf16 v[96:99], a[140:143], v[172:175], v[36:39]
    v_exp_f32 v106, v106
    v_mfma_f32_16x16x32_bf16 v[96:99], a[136:139], v[168:171], v[96:99]
    v_exp_f32 v107, v107
    v_cvt_pk_bf16_f32 v60, v104, v105
    v_mfma_f32_16x16x32_bf16 v[96:99], a[132:135], v[164:167], v[96:99]
    v_exp_f32 v100, v100
    v_exp_f32 v101, v101
    v_mfma_f32_16x16x32_bf16 v[96:99], a[128:131], v[160:163], v[96:99]
    v_cvt_pk_bf16_f32 v61, v106, v107
    v_exp_f32 v102, v102
    v_mfma_f32_16x16x32_bf16 a[16:19], v[48:51], a[224:227], 0
    v_exp_f32 v103, v103
    v_mfma_f32_16x16x32_bf16 a[16:19], v[52:55], a[228:231], a[16:19]
    v_cvt_pk_bf16_f32 v58, v100, v101
    v_mfma_f32_16x16x32_bf16 a[20:23], v[52:55], a[236:239], 0
    s_nop 0
    v_exp_f32 v96, v96
    v_mfma_f32_16x16x32_bf16 a[20:23], v[48:51], a[232:235], a[20:23]
    v_exp_f32 v97, v97
    v_mfma_f32_16x16x32_bf16 a[24:27], v[48:51], a[240:243], 0
    v_cvt_pk_bf16_f32 v59, v102, v103
    v_mfma_f32_16x16x32_bf16 a[24:27], v[52:55], a[244:247], a[24:27]
    v_exp_f32 v98, v98
    v_mfma_f32_16x16x32_bf16 a[28:31], v[52:55], a[252:255], 0
    v_exp_f32 v99, v99
    v_mfma_f32_16x16x32_bf16 a[28:31], v[48:51], a[248:251], a[28:31]
    v_cvt_pk_bf16_f32 v56, v96, v97
    v_cvt_pk_bf16_f32 v57, v98, v99
    v_smfmac_f32_16x16x64_bf16 v[220:223], v[216:219], v[48:55], v15
    s_waitcnt vmcnt(8)
    ds_read_b128 v[176:179], v28 offset:8192
    ds_read_b128 v[180:183], v29 offset:8192
    ds_read_b128 v[184:187], v30 offset:8192
    ds_read_b128 v[188:191], v31 offset:8192
    s_mov_b32 m0, s100
    s_mov_b32 s33, 16384
    buffer_load_dwordx4 v12, s[16:19], s33 offen lds
    buffer_load_dwordx4 v13, s[16:19], s33 offen offset:1024 lds
    buffer_load_dwordx4 v12, s[16:19], s33 offen offset:2048 lds
    buffer_load_dwordx4 v13, s[16:19], s33 offen offset:3072 lds
    s_waitcnt lgkmcnt(0)
    v_lshlrev_b32 v236, 16, v176
    v_and_b32 v237, s43, v176
    v_lshlrev_b32 v238, 16, v177
    v_and_b32 v239, s43, v177
    v_lshlrev_b32 v240, 16, v178
    v_and_b32 v241, s43, v178
    v_lshlrev_b32 v242, 16, v179
    v_and_b32 v243, s43, v179
    v_pk_mul_f32 v[236:237], v[236:237], s[34:35]
    v_pk_mul_f32 v[238:239], v[238:239], s[34:35]
    v_pk_mul_f32 v[240:241], v[240:241], s[34:35]
    v_pk_mul_f32 v[242:243], v[242:243], s[34:35]
    v_cvt_pk_bf16_f32 v176, v236, v237
    v_cvt_pk_bf16_f32 v177, v238, v239
    v_cvt_pk_bf16_f32 v178, v240, v241
    v_cvt_pk_bf16_f32 v179, v242, v243
    v_lshlrev_b32 v244, 16, v180
    v_and_b32 v245, s43, v180
    v_lshlrev_b32 v246, 16, v181
    v_and_b32 v247, s43, v181
    v_lshlrev_b32 v248, 16, v182
    v_and_b32 v249, s43, v182
    v_lshlrev_b32 v250, 16, v183
    v_and_b32 v251, s43, v183
    v_pk_mul_f32 v[244:245], v[244:245], s[34:35]
    v_pk_mul_f32 v[246:247], v[246:247], s[34:35]
    v_pk_mul_f32 v[248:249], v[248:249], s[34:35]
    v_pk_mul_f32 v[250:251], v[250:251], s[34:35]
    v_cvt_pk_bf16_f32 v180, v244, v245
    v_cvt_pk_bf16_f32 v181, v246, v247
    v_cvt_pk_bf16_f32 v182, v248, v249
    v_cvt_pk_bf16_f32 v183, v250, v251
    v_lshlrev_b32 v236, 16, v184
    v_and_b32 v237, s43, v184
    v_lshlrev_b32 v238, 16, v185
    v_and_b32 v239, s43, v185
    v_lshlrev_b32 v240, 16, v186
    v_and_b32 v241, s43, v186
    v_lshlrev_b32 v242, 16, v187
    v_and_b32 v243, s43, v187
    v_pk_mul_f32 v[236:237], v[236:237], s[34:35]
    v_pk_mul_f32 v[238:239], v[238:239], s[34:35]
    v_pk_mul_f32 v[240:241], v[240:241], s[34:35]
    v_pk_mul_f32 v[242:243], v[242:243], s[34:35]
    v_cvt_pk_bf16_f32 v184, v236, v237
    v_cvt_pk_bf16_f32 v185, v238, v239
    v_cvt_pk_bf16_f32 v186, v240, v241
    v_cvt_pk_bf16_f32 v187, v242, v243
    v_lshlrev_b32 v244, 16, v188
    v_and_b32 v245, s43, v188
    v_lshlrev_b32 v246, 16, v189
    v_and_b32 v247, s43, v189
    v_lshlrev_b32 v248, 16, v190
    v_and_b32 v249, s43, v190
    v_lshlrev_b32 v250, 16, v191
    v_and_b32 v251, s43, v191
    v_pk_mul_f32 v[244:245], v[244:245], s[34:35]
    v_pk_mul_f32 v[246:247], v[246:247], s[34:35]
    v_pk_mul_f32 v[248:249], v[248:249], s[34:35]
    v_pk_mul_f32 v[250:251], v[250:251], s[34:35]
    v_cvt_pk_bf16_f32 v188, v244, v245
    v_cvt_pk_bf16_f32 v189, v246, v247
    v_cvt_pk_bf16_f32 v190, v248, v249
    v_cvt_pk_bf16_f32 v191, v250, v251
    s_waitcnt lgkmcnt(0)
    v_mfma_f32_16x16x32_bf16 v[112:115], a[128:131], v[176:179], v[40:43]
    v_mfma_f32_16x16x32_bf16 v[112:115], a[132:135], v[180:183], v[112:115]
    v_mfma_f32_16x16x32_bf16 v[112:115], a[136:139], v[184:187], v[112:115]
    v_mfma_f32_16x16x32_bf16 v[112:115], a[140:143], v[188:191], v[112:115]
    v_mfma_f32_16x16x32_bf16 a[60:63], v[56:59], a[248:251], 0
    v_mfma_f32_16x16x32_bf16 a[60:63], v[60:63], a[252:255], a[60:63]
    s_nop 2
    s_nop 0
    s_nop 0
    s_nop 0
    v_max3_f32 v2, v112, v113, v114
    v_max_f32 v2, v2, v115
    v_mov_b32 v4, v2
    v_mfma_f32_16x16x32_bf16 a[56:59], v[60:63], a[244:247], 0
    s_nop 0
    v_permlane32_swap_b32 v2, v4
    v_max_f32 v2, v2, v4
    v_mov_b32 v4, v2
    v_mfma_f32_16x16x32_bf16 a[56:59], v[56:59], a[240:243], a[56:59]
    s_nop 0
    v_permlane16_swap_b32 v2, v4
    v_max_f32 v2, v2, v4
    v_add_f32 v2, 0x420c0000, v2
    v_mfma_f32_16x16x32_bf16 a[52:55], v[56:59], a[232:235], 0
    v_cndmask_b32 v2, 0, v2, s[48:49]
    v_sub_f32 v40, v40, v2
    v_sub_f32 v41, v41, v2
    v_mfma_f32_16x16x32_bf16 a[52:55], v[60:63], a[236:239], a[52:55]
    v_sub_f32 v42, v42, v2
    v_sub_f32 v43, v43, v2
    v_mfma_f32_16x16x32_bf16 a[48:51], v[60:63], a[228:231], 0
    v_sub_f32 v112, v112, v2
    v_sub_f32 v113, v113, v2
    v_mfma_f32_16x16x32_bf16 a[48:51], v[56:59], a[224:227], a[48:51]
    v_sub_f32 v114, v114, v2
    v_sub_f32 v115, v115, v2
    v_mfma_f32_16x16x32_bf16 v[116:119], a[156:159], v[188:191], v[40:43]
    s_mov_b32 m0, s98
    s_mov_b32 s33, 32768
    v_mfma_f32_16x16x32_bf16 v[116:119], a[152:155], v[184:187], v[116:119]
    buffer_load_dwordx4 v12, s[12:15], s33 offen lds
    v_exp_f32 v112, v112
    v_mfma_f32_16x16x32_bf16 v[116:119], a[148:151], v[180:183], v[116:119]
    buffer_load_dwordx4 v13, s[12:15], s33 offen offset:1024 lds
    v_mfma_f32_16x16x32_bf16 v[116:119], a[144:147], v[176:179], v[116:119]
    buffer_load_dwordx4 v12, s[12:15], s33 offen offset:2048 lds
    v_exp_f32 v113, v113
    v_mfma_f32_16x16x32_bf16 v[120:123], a[160:163], v[176:179], v[40:43]
    buffer_load_dwordx4 v13, s[12:15], s33 offen offset:3072 lds
    v_mfma_f32_16x16x32_bf16 v[120:123], a[164:167], v[180:183], v[120:123]
    v_exp_f32 v114, v114
    v_exp_f32 v115, v115
    v_mfma_f32_16x16x32_bf16 v[120:123], a[168:171], v[184:187], v[120:123]
    v_cvt_pk_bf16_f32 v64, v112, v113
    v_exp_f32 v116, v116
    v_mfma_f32_16x16x32_bf16 v[120:123], a[172:175], v[188:191], v[120:123]
    v_exp_f32 v117, v117
    v_cvt_pk_bf16_f32 v65, v114, v115
    v_mfma_f32_16x16x32_bf16 v[124:127], a[188:191], v[188:191], v[40:43]
    v_exp_f32 v118, v118
    v_mfma_f32_16x16x32_bf16 v[124:127], a[184:187], v[184:187], v[124:127]
    v_exp_f32 v119, v119
    v_cvt_pk_bf16_f32 v66, v116, v117
    v_mfma_f32_16x16x32_bf16 v[124:127], a[180:183], v[180:183], v[124:127]
    v_exp_f32 v120, v120
    v_exp_f32 v121, v121
    v_mfma_f32_16x16x32_bf16 v[124:127], a[176:179], v[176:179], v[124:127]
    v_cvt_pk_bf16_f32 v67, v118, v119
    v_exp_f32 v122, v122
    v_mfma_f32_16x16x32_bf16 a[44:47], v[56:59], a[216:219], 0
    v_exp_f32 v123, v123
    v_mfma_f32_16x16x32_bf16 a[44:47], v[60:63], a[220:223], a[44:47]
    v_cvt_pk_bf16_f32 v68, v120, v121
    v_mfma_f32_16x16x32_bf16 a[40:43], v[60:63], a[212:215], 0
    s_nop 0
    v_exp_f32 v124, v124
    v_mfma_f32_16x16x32_bf16 a[40:43], v[56:59], a[208:211], a[40:43]
    v_exp_f32 v125, v125
    v_mfma_f32_16x16x32_bf16 a[36:39], v[56:59], a[200:203], 0
    v_cvt_pk_bf16_f32 v69, v122, v123
    v_mfma_f32_16x16x32_bf16 a[36:39], v[60:63], a[204:207], a[36:39]
    v_exp_f32 v126, v126
    v_mfma_f32_16x16x32_bf16 a[32:35], v[60:63], a[196:199], 0
    v_exp_f32 v127, v127
    v_mfma_f32_16x16x32_bf16 a[32:35], v[56:59], a[192:195], a[32:35]
    v_cvt_pk_bf16_f32 v70, v124, v125
    v_cvt_pk_bf16_f32 v71, v126, v127
    v_smfmac_f32_16x16x64_bf16 v[224:227], v[216:219], v[56:63], v15
    s_waitcnt vmcnt(12)
    ds_read_b128 v[192:195], v28 offset:12288
    ds_read_b128 v[196:199], v29 offset:12288
    ds_read_b128 v[200:203], v30 offset:12288
    ds_read_b128 v[204:207], v31 offset:12288
    s_mov_b32 m0, s101
    s_mov_b32 s33, 32768
    buffer_load_dwordx4 v12, s[16:19], s33 offen lds
    buffer_load_dwordx4 v13, s[16:19], s33 offen offset:1024 lds
    buffer_load_dwordx4 v12, s[16:19], s33 offen offset:2048 lds
    buffer_load_dwordx4 v13, s[16:19], s33 offen offset:3072 lds
    s_waitcnt lgkmcnt(0)
    v_lshlrev_b32 v236, 16, v192
    v_and_b32 v237, s43, v192
    v_lshlrev_b32 v238, 16, v193
    v_and_b32 v239, s43, v193
    v_lshlrev_b32 v240, 16, v194
    v_and_b32 v241, s43, v194
    v_lshlrev_b32 v242, 16, v195
    v_and_b32 v243, s43, v195
    v_pk_mul_f32 v[236:237], v[236:237], s[34:35]
    v_pk_mul_f32 v[238:239], v[238:239], s[34:35]
    v_pk_mul_f32 v[240:241], v[240:241], s[34:35]
    v_pk_mul_f32 v[242:243], v[242:243], s[34:35]
    v_cvt_pk_bf16_f32 v192, v236, v237
    v_cvt_pk_bf16_f32 v193, v238, v239
    v_cvt_pk_bf16_f32 v194, v240, v241
    v_cvt_pk_bf16_f32 v195, v242, v243
    v_lshlrev_b32 v244, 16, v196
    v_and_b32 v245, s43, v196
    v_lshlrev_b32 v246, 16, v197
    v_and_b32 v247, s43, v197
    v_lshlrev_b32 v248, 16, v198
    v_and_b32 v249, s43, v198
    v_lshlrev_b32 v250, 16, v199
    v_and_b32 v251, s43, v199
    v_pk_mul_f32 v[244:245], v[244:245], s[34:35]
    v_pk_mul_f32 v[246:247], v[246:247], s[34:35]
    v_pk_mul_f32 v[248:249], v[248:249], s[34:35]
    v_pk_mul_f32 v[250:251], v[250:251], s[34:35]
    v_cvt_pk_bf16_f32 v196, v244, v245
    v_cvt_pk_bf16_f32 v197, v246, v247
    v_cvt_pk_bf16_f32 v198, v248, v249
    v_cvt_pk_bf16_f32 v199, v250, v251
    v_lshlrev_b32 v236, 16, v200
    v_and_b32 v237, s43, v200
    v_lshlrev_b32 v238, 16, v201
    v_and_b32 v239, s43, v201
    v_lshlrev_b32 v240, 16, v202
    v_and_b32 v241, s43, v202
    v_lshlrev_b32 v242, 16, v203
    v_and_b32 v243, s43, v203
    v_pk_mul_f32 v[236:237], v[236:237], s[34:35]
    v_pk_mul_f32 v[238:239], v[238:239], s[34:35]
    v_pk_mul_f32 v[240:241], v[240:241], s[34:35]
    v_pk_mul_f32 v[242:243], v[242:243], s[34:35]
    v_cvt_pk_bf16_f32 v200, v236, v237
    v_cvt_pk_bf16_f32 v201, v238, v239
    v_cvt_pk_bf16_f32 v202, v240, v241
    v_cvt_pk_bf16_f32 v203, v242, v243
    v_lshlrev_b32 v244, 16, v204
    v_and_b32 v245, s43, v204
    v_lshlrev_b32 v246, 16, v205
    v_and_b32 v247, s43, v205
    v_lshlrev_b32 v248, 16, v206
    v_and_b32 v249, s43, v206
    v_lshlrev_b32 v250, 16, v207
    v_and_b32 v251, s43, v207
    v_pk_mul_f32 v[244:245], v[244:245], s[34:35]
    v_pk_mul_f32 v[246:247], v[246:247], s[34:35]
    v_pk_mul_f32 v[248:249], v[248:249], s[34:35]
    v_pk_mul_f32 v[250:251], v[250:251], s[34:35]
    v_cvt_pk_bf16_f32 v204, v244, v245
    v_cvt_pk_bf16_f32 v205, v246, v247
    v_cvt_pk_bf16_f32 v206, v248, v249
    v_cvt_pk_bf16_f32 v207, v250, v251
    s_waitcnt lgkmcnt(0)
    v_mfma_f32_16x16x32_bf16 v[140:143], a[176:179], v[192:195], v[44:47]
    v_mfma_f32_16x16x32_bf16 v[140:143], a[180:183], v[196:199], v[140:143]
    v_mfma_f32_16x16x32_bf16 v[140:143], a[184:187], v[200:203], v[140:143]
    v_mfma_f32_16x16x32_bf16 v[140:143], a[188:191], v[204:207], v[140:143]
    v_mfma_f32_16x16x32_bf16 a[64:67], v[64:67], a[192:195], 0
    v_mfma_f32_16x16x32_bf16 a[64:67], v[68:71], a[196:199], a[64:67]
    s_nop 2
    s_nop 0
    s_nop 0
    s_nop 0
    v_max3_f32 v2, v140, v141, v142
    v_max_f32 v2, v2, v143
    v_mov_b32 v4, v2
    v_mfma_f32_16x16x32_bf16 a[68:71], v[68:71], a[204:207], 0
    s_nop 0
    v_permlane32_swap_b32 v2, v4
    v_max_f32 v2, v2, v4
    v_mov_b32 v4, v2
    v_mfma_f32_16x16x32_bf16 a[68:71], v[64:67], a[200:203], a[68:71]
    s_nop 0
    v_permlane16_swap_b32 v2, v4
    v_max_f32 v2, v2, v4
    v_add_f32 v2, 0x420c0000, v2
    v_mfma_f32_16x16x32_bf16 a[72:75], v[64:67], a[208:211], 0
    v_cndmask_b32 v2, 0, v2, s[48:49]
    v_sub_f32 v44, v44, v2
    v_sub_f32 v45, v45, v2
    v_mfma_f32_16x16x32_bf16 a[72:75], v[68:71], a[212:215], a[72:75]
    v_sub_f32 v46, v46, v2
    v_sub_f32 v47, v47, v2
    v_mfma_f32_16x16x32_bf16 a[76:79], v[68:71], a[220:223], 0
    v_sub_f32 v140, v140, v2
    v_sub_f32 v141, v141, v2
    v_mfma_f32_16x16x32_bf16 a[76:79], v[64:67], a[216:219], a[76:79]
    v_sub_f32 v142, v142, v2
    v_sub_f32 v143, v143, v2
    v_mfma_f32_16x16x32_bf16 v[136:139], a[172:175], v[204:207], v[44:47]
    s_mov_b32 m0, s96
    s_mov_b32 s33, 49152
    v_mfma_f32_16x16x32_bf16 v[136:139], a[168:171], v[200:203], v[136:139]
    buffer_load_dwordx4 v12, s[12:15], s33 offen lds
    v_mfma_f32_16x16x32_bf16 v[136:139], a[164:167], v[196:199], v[136:139]
    buffer_load_dwordx4 v13, s[12:15], s33 offen offset:1024 lds
    v_mfma_f32_16x16x32_bf16 v[136:139], a[160:163], v[192:195], v[136:139]
    buffer_load_dwordx4 v12, s[12:15], s33 offen offset:2048 lds
    v_mfma_f32_16x16x32_bf16 v[132:135], a[144:147], v[192:195], v[44:47]
    buffer_load_dwordx4 v13, s[12:15], s33 offen offset:3072 lds
    v_mfma_f32_16x16x32_bf16 v[132:135], a[148:151], v[196:199], v[132:135]
    v_exp_f32 v140, v140
    v_mfma_f32_16x16x32_bf16 v[132:135], a[152:155], v[200:203], v[132:135]
    v_exp_f32 v141, v141
    v_mfma_f32_16x16x32_bf16 v[132:135], a[156:159], v[204:207], v[132:135]
    v_exp_f32 v142, v142
    v_mfma_f32_16x16x32_bf16 v[128:131], a[140:143], v[204:207], v[44:47]
    v_exp_f32 v143, v143
    v_cvt_pk_bf16_f32 v78, v140, v141
    v_mfma_f32_16x16x32_bf16 v[128:131], a[136:139], v[200:203], v[128:131]
    v_exp_f32 v136, v136
    v_exp_f32 v137, v137
    v_mfma_f32_16x16x32_bf16 v[128:131], a[132:135], v[196:199], v[128:131]
    v_cvt_pk_bf16_f32 v79, v142, v143
    v_exp_f32 v138, v138
    v_mfma_f32_16x16x32_bf16 v[128:131], a[128:131], v[192:195], v[128:131]
    v_exp_f32 v139, v139
    v_cvt_pk_bf16_f32 v76, v136, v137
    s_waitcnt vmcnt(16)
    s_barrier
    v_mfma_f32_16x16x32_bf16 a[80:83], v[64:67], a[224:227], 0
    ds_read_b128 a[176:179], v16 offset:28672
    ds_read_b128 a[180:183], v17 offset:28672
    ds_read_b128 a[184:187], v18 offset:28672
    v_exp_f32 v132, v132
    v_mfma_f32_16x16x32_bf16 a[80:83], v[68:71], a[228:231], a[80:83]
    ds_read_b128 a[188:191], v19 offset:28672
    ds_read_b128 a[172:175], v19 offset:24576
    ds_read_b128 a[168:171], v18 offset:24576
    v_mfma_f32_16x16x32_bf16 a[84:87], v[68:71], a[236:239], 0
    ds_read_b128 a[164:167], v17 offset:24576
    ds_read_b128 a[160:163], v16 offset:24576
    ds_read_b128 a[144:147], v16 offset:20480
    v_exp_f32 v133, v133
    v_mfma_f32_16x16x32_bf16 a[84:87], v[64:67], a[232:235], a[84:87]
    ds_read_b128 a[148:151], v17 offset:20480
    ds_read_b128 a[152:155], v18 offset:20480
    ds_read_b128 a[156:159], v19 offset:20480
    v_cvt_pk_bf16_f32 v77, v138, v139
    v_mfma_f32_16x16x32_bf16 a[88:91], v[64:67], a[240:243], 0
    ds_read_b128 a[140:143], v19 offset:16384
    ds_read_b128 a[136:139], v18 offset:16384
    ds_read_b128 a[132:135], v17 offset:16384
    v_mfma_f32_16x16x32_bf16 a[88:91], v[68:71], a[244:247], a[88:91]
    ds_read_b128 a[128:131], v16 offset:16384
    v_exp_f32 v134, v134
    v_exp_f32 v135, v135
    v_mfma_f32_16x16x32_bf16 a[92:95], v[68:71], a[252:255], 0
    v_cvt_pk_bf16_f32 v74, v132, v133
    v_exp_f32 v128, v128
    v_mfma_f32_16x16x32_bf16 a[92:95], v[64:67], a[248:251], a[92:95]
    v_exp_f32 v129, v129
    v_cvt_pk_bf16_f32 v75, v134, v135
    v_exp_f32 v130, v130
    v_smfmac_f32_16x16x64_bf16 v[228:231], v[216:219], v[64:71], v15
    v_exp_f32 v131, v131
    v_cvt_pk_bf16_f32 v72, v128, v129
    v_cvt_pk_bf16_f32 v73, v130, v131
    s_mov_b32 s30, 65536
    s_mov_b32 m0, s99
    s_mov_b32 s31, 0
    s_add_u32 s6, s16, 49152
    s_addc_u32 s7, s17, 0
    s_add_u32 s4, s12, 65536
    s_addc_u32 s5, s13, 0
    s_waitcnt vmcnt(8) lgkmcnt(0)
    s_barrier
    v_mfma_f32_16x16x32_bf16 a[124:127], v[72:75], a[248:251], 0
    v_mfma_f32_16x16x32_bf16 a[124:127], v[76:79], a[252:255], a[124:127]
    v_mfma_f32_16x16x32_bf16 a[120:123], v[76:79], a[244:247], 0
    v_mfma_f32_16x16x32_bf16 a[120:123], v[72:75], a[240:243], a[120:123]
    global_load_lds_dwordx4 v12, s[6:7]
    v_mfma_f32_16x16x32_bf16 a[116:119], v[72:75], a[232:235], 0
    ds_read_b64_tr_b16 a[248:249], v27 offset:16384
    v_mfma_f32_16x16x32_bf16 a[116:119], v[76:79], a[236:239], a[116:119]
    ds_read_b64_tr_b16 a[250:251], v27 offset:20480
    v_mfma_f32_16x16x32_bf16 a[112:115], v[76:79], a[228:231], 0
    ds_read_b64_tr_b16 a[252:253], v27 offset:24576
    v_mfma_f32_16x16x32_bf16 a[112:115], v[72:75], a[224:227], a[112:115]
    global_load_lds_dwordx4 v13, s[6:7] offset:1024
    v_mfma_f32_16x16x32_bf16 a[108:111], v[72:75], a[216:219], 0
    ds_read_b64_tr_b16 a[254:255], v27 offset:28672
    v_mfma_f32_16x16x32_bf16 a[108:111], v[76:79], a[220:223], a[108:111]
    ds_read_b64_tr_b16 a[240:241], v26 offset:16384
    v_mfma_f32_16x16x32_bf16 a[104:107], v[76:79], a[212:215], 0
    ds_read_b64_tr_b16 a[242:243], v26 offset:20480
    v_mfma_f32_16x16x32_bf16 a[104:107], v[72:75], a[208:211], a[104:107]
    global_load_lds_dwordx4 v12, s[6:7] offset:2048
    v_mfma_f32_16x16x32_bf16 a[100:103], v[72:75], a[200:203], 0
    ds_read_b64_tr_b16 a[244:245], v26 offset:24576
    v_mfma_f32_16x16x32_bf16 a[100:103], v[76:79], a[204:207], a[100:103]
    ds_read_b64_tr_b16 a[246:247], v26 offset:28672
    v_mfma_f32_16x16x32_bf16 a[96:99], v[76:79], a[196:199], 0
    ds_read_b64_tr_b16 a[232:233], v25 offset:16384
    v_mfma_f32_16x16x32_bf16 a[96:99], v[72:75], a[192:195], a[96:99]
    global_load_lds_dwordx4 v13, s[6:7] offset:3072
    v_smfmac_f32_16x16x64_bf16 v[232:235], v[216:219], v[72:79], v15
    s_mov_b32 m0, s97
L_loop:
    v_mfma_f32_16x16x32_bf16 v[80:83], a[128:131], v[144:147], v[32:35]
    ds_read_b64_tr_b16 a[234:235], v25 offset:20480
    v_mfma_f32_16x16x32_bf16 v[80:83], a[132:135], v[148:151], v[80:83]
    ds_read_b64_tr_b16 a[236:237], v25 offset:24576
    v_mfma_f32_16x16x32_bf16 v[80:83], a[136:139], v[152:155], v[80:83]
    ds_read_b64_tr_b16 a[238:239], v25 offset:28672
    v_mfma_f32_16x16x32_bf16 v[80:83], a[140:143], v[156:159], v[80:83]
    global_load_lds_dwordx4 v12, s[4:5]
    v_mfma_f32_16x16x32_bf16 v[84:87], a[156:159], v[156:159], v[32:35]
    ds_read_b64_tr_b16 a[224:225], v24 offset:16384
    v_mfma_f32_16x16x32_bf16 v[84:87], a[152:155], v[152:155], v[84:87]
    ds_read_b64_tr_b16 a[226:227], v24 offset:20480
    v_mfma_f32_16x16x32_bf16 v[84:87], a[148:151], v[148:151], v[84:87]
    ds_read_b64_tr_b16 a[228:229], v24 offset:24576
    v_mfma_f32_16x16x32_bf16 v[84:87], a[144:147], v[144:147], v[84:87]
    global_load_lds_dwordx4 v13, s[4:5] offset:1024
    v_mfma_f32_16x16x32_bf16 v[88:91], a[160:163], v[144:147], v[32:35]
    ds_read_b64_tr_b16 a[230:231], v24 offset:28672
    v_mfma_f32_16x16x32_bf16 v[88:91], a[164:167], v[148:151], v[88:91]
    ds_read_b64_tr_b16 a[216:217], v23 offset:16384
    v_mfma_f32_16x16x32_bf16 v[88:91], a[168:171], v[152:155], v[88:91]
    ds_read_b64_tr_b16 a[218:219], v23 offset:20480
    v_mfma_f32_16x16x32_bf16 v[88:91], a[172:175], v[156:159], v[88:91]
    global_load_lds_dwordx4 v12, s[4:5] offset:2048
    v_mfma_f32_16x16x32_bf16 v[92:95], a[188:191], v[156:159], v[32:35]
    ds_read_b64_tr_b16 a[220:221], v23 offset:24576
    v_mfma_f32_16x16x32_bf16 v[92:95], a[184:187], v[152:155], v[92:95]
    ds_read_b64_tr_b16 a[222:223], v23 offset:28672
    v_mfma_f32_16x16x32_bf16 v[92:95], a[180:183], v[148:151], v[92:95]
    ds_read_b64_tr_b16 a[208:209], v22 offset:16384
    v_mfma_f32_16x16x32_bf16 v[92:95], a[176:179], v[144:147], v[92:95]
    global_load_lds_dwordx4 v13, s[4:5] offset:3072
    v_mfma_f32_16x16x32_bf16 v[108:111], a[176:179], v[160:163], v[36:39]
    ds_read_b64_tr_b16 a[210:211], v22 offset:20480
    v_mfma_f32_16x16x32_bf16 v[108:111], a[180:183], v[164:167], v[108:111]
    v_exp_f32 v80, v80
    v_mfma_f32_16x16x32_bf16 v[108:111], a[184:187], v[168:171], v[108:111]
    v_exp_f32 v81, v81
    v_mfma_f32_16x16x32_bf16 v[108:111], a[188:191], v[172:175], v[108:111]
    ds_read_b64_tr_b16 a[212:213], v22 offset:24576
    s_mov_b32 m0, s100
    v_mfma_f32_16x16x32_bf16 v[104:107], a[172:175], v[172:175], v[36:39]
    v_exp_f32 v82, v82
    v_mfma_f32_16x16x32_bf16 v[104:107], a[168:171], v[168:171], v[104:107]
    v_exp_f32 v83, v83
    v_mfma_f32_16x16x32_bf16 v[104:107], a[164:167], v[164:167], v[104:107]
    ds_read_b64_tr_b16 a[214:215], v22 offset:28672
    v_cvt_pk_bf16_f32 v48, v80, v81
    v_mfma_f32_16x16x32_bf16 v[104:107], a[160:163], v[160:163], v[104:107]
    v_exp_f32 v84, v84
    v_mfma_f32_16x16x32_bf16 v[100:103], a[144:147], v[160:163], v[36:39]
    v_exp_f32 v85, v85
    v_mfma_f32_16x16x32_bf16 v[100:103], a[148:151], v[164:167], v[100:103]
    ds_read_b64_tr_b16 a[200:201], v21 offset:16384
    v_cvt_pk_bf16_f32 v49, v82, v83
    v_mfma_f32_16x16x32_bf16 v[100:103], a[152:155], v[168:171], v[100:103]
    v_exp_f32 v86, v86
    v_mfma_f32_16x16x32_bf16 v[100:103], a[156:159], v[172:175], v[100:103]
    v_exp_f32 v87, v87
    v_mfma_f32_16x16x32_bf16 v[96:99], a[140:143], v[172:175], v[36:39]
    ds_read_b64_tr_b16 a[202:203], v21 offset:20480
    v_cvt_pk_bf16_f32 v50, v84, v85
    v_mfma_f32_16x16x32_bf16 v[96:99], a[136:139], v[168:171], v[96:99]
    v_exp_f32 v88, v88
    v_mfma_f32_16x16x32_bf16 v[96:99], a[132:135], v[164:167], v[96:99]
    v_exp_f32 v89, v89
    v_mfma_f32_16x16x32_bf16 v[96:99], a[128:131], v[160:163], v[96:99]
    ds_read_b64_tr_b16 a[204:205], v21 offset:24576
    v_cvt_pk_bf16_f32 v51, v86, v87
    v_mfma_f32_16x16x32_bf16 v[112:115], a[128:131], v[176:179], v[40:43]
    v_exp_f32 v90, v90
    v_mfma_f32_16x16x32_bf16 v[112:115], a[132:135], v[180:183], v[112:115]
    v_exp_f32 v91, v91
    v_mfma_f32_16x16x32_bf16 v[112:115], a[136:139], v[184:187], v[112:115]
    ds_read_b64_tr_b16 a[206:207], v21 offset:28672
    v_cvt_pk_bf16_f32 v52, v88, v89
    v_mfma_f32_16x16x32_bf16 v[112:115], a[140:143], v[188:191], v[112:115]
    v_exp_f32 v92, v92
    v_mfma_f32_16x16x32_bf16 v[116:119], a[156:159], v[188:191], v[40:43]
    v_exp_f32 v93, v93
    v_mfma_f32_16x16x32_bf16 v[116:119], a[152:155], v[184:187], v[116:119]
    ds_read_b64_tr_b16 a[192:193], v20 offset:16384
    v_cvt_pk_bf16_f32 v53, v90, v91
    v_mfma_f32_16x16x32_bf16 v[116:119], a[148:151], v[180:183], v[116:119]
    v_exp_f32 v94, v94
    v_mfma_f32_16x16x32_bf16 v[116:119], a[144:147], v[176:179], v[116:119]
    v_exp_f32 v95, v95
    v_mfma_f32_16x16x32_bf16 v[120:123], a[160:163], v[176:179], v[40:43]
    ds_read_b64_tr_b16 a[194:195], v20 offset:20480
    v_cvt_pk_bf16_f32 v54, v92, v93
    v_mfma_f32_16x16x32_bf16 v[120:123], a[164:167], v[180:183], v[120:123]
    v_exp_f32 v108, v108
    v_mfma_f32_16x16x32_bf16 v[120:123], a[168:171], v[184:187], v[120:123]
    v_exp_f32 v109, v109
    v_mfma_f32_16x16x32_bf16 v[120:123], a[172:175], v[188:191], v[120:123]
    ds_read_b64_tr_b16 a[196:197], v20 offset:24576
    v_cvt_pk_bf16_f32 v55, v94, v95
    v_mfma_f32_16x16x32_bf16 v[124:127], a[188:191], v[188:191], v[40:43]
    v_exp_f32 v110, v110
    v_mfma_f32_16x16x32_bf16 v[124:127], a[184:187], v[184:187], v[124:127]
    v_exp_f32 v111, v111
    v_mfma_f32_16x16x32_bf16 v[124:127], a[180:183], v[180:183], v[124:127]
    ds_read_b64_tr_b16 a[198:199], v20 offset:28672
    v_cvt_pk_bf16_f32 v62, v108, v109
    v_mfma_f32_16x16x32_bf16 v[124:127], a[176:179], v[176:179], v[124:127]
    v_exp_f32 v104, v104
    v_mfma_f32_16x16x32_bf16 v[140:143], a[176:179], v[192:195], v[44:47]
    v_exp_f32 v105, v105
    v_mfma_f32_16x16x32_bf16 v[140:143], a[180:183], v[196:199], v[140:143]
    s_add_u32 s6, s16, s30
    v_cvt_pk_bf16_f32 v63, v110, v111
    v_mfma_f32_16x16x32_bf16 v[140:143], a[184:187], v[200:203], v[140:143]
    v_exp_f32 v106, v106
    v_mfma_f32_16x16x32_bf16 v[140:143], a[188:191], v[204:207], v[140:143]
    v_exp_f32 v107, v107
    v_mfma_f32_16x16x32_bf16 v[136:139], a[172:175], v[204:207], v[44:47]
    s_addc_u32 s7, s17, 0
    v_cvt_pk_bf16_f32 v60, v104, v105
    v_mfma_f32_16x16x32_bf16 v[136:139], a[168:171], v[200:203], v[136:139]
    v_exp_f32 v100, v100
    v_mfma_f32_16x16x32_bf16 v[136:139], a[164:167], v[196:199], v[136:139]
    v_exp_f32 v101, v101
    v_mfma_f32_16x16x32_bf16 v[136:139], a[160:163], v[192:195], v[136:139]
    s_add_u32 s30, s30, 16384
    v_cvt_pk_bf16_f32 v61, v106, v107
    v_mfma_f32_16x16x32_bf16 v[132:135], a[144:147], v[192:195], v[44:47]
    v_exp_f32 v102, v102
    v_mfma_f32_16x16x32_bf16 v[132:135], a[148:151], v[196:199], v[132:135]
    v_exp_f32 v103, v103
    v_mfma_f32_16x16x32_bf16 v[132:135], a[152:155], v[200:203], v[132:135]
    s_and_b32 s30, s30, 0x7ffff
    v_cvt_pk_bf16_f32 v58, v100, v101
    v_mfma_f32_16x16x32_bf16 v[132:135], a[156:159], v[204:207], v[132:135]
    v_exp_f32 v96, v96
    v_mfma_f32_16x16x32_bf16 v[128:131], a[140:143], v[204:207], v[44:47]
    v_exp_f32 v97, v97
    v_mfma_f32_16x16x32_bf16 v[128:131], a[136:139], v[200:203], v[128:131]
    v_cvt_pk_bf16_f32 v59, v102, v103
    s_waitcnt lgkmcnt(0)
    v_mfma_f32_16x16x32_bf16 v[128:131], a[132:135], v[196:199], v[128:131]
    v_exp_f32 v98, v98
    v_mfma_f32_16x16x32_bf16 v[128:131], a[128:131], v[192:195], v[128:131]
    v_exp_f32 v99, v99
    v_mfma_f32_16x16x32_bf16 a[0:3], v[48:51], a[192:195], a[0:3]
    ds_read_b128 a[176:179], v16 offset:45056
    v_cvt_pk_bf16_f32 v56, v96, v97
    v_mfma_f32_16x16x32_bf16 a[0:3], v[52:55], a[196:199], a[0:3]
    v_exp_f32 v112, v112
    v_mfma_f32_16x16x32_bf16 a[4:7], v[52:55], a[204:207], a[4:7]
    v_exp_f32 v113, v113
    v_mfma_f32_16x16x32_bf16 a[4:7], v[48:51], a[200:203], a[4:7]
    ds_read_b128 a[180:183], v17 offset:45056
    v_cvt_pk_bf16_f32 v57, v98, v99
    v_mfma_f32_16x16x32_bf16 a[8:11], v[48:51], a[208:211], a[8:11]
    v_exp_f32 v114, v114
    v_mfma_f32_16x16x32_bf16 a[8:11], v[52:55], a[212:215], a[8:11]
    v_exp_f32 v115, v115
    v_mfma_f32_16x16x32_bf16 a[12:15], v[52:55], a[220:223], a[12:15]
    ds_read_b128 a[184:187], v18 offset:45056
    v_cvt_pk_bf16_f32 v64, v112, v113
    v_mfma_f32_16x16x32_bf16 a[12:15], v[48:51], a[216:219], a[12:15]
    v_exp_f32 v116, v116
    v_mfma_f32_16x16x32_bf16 a[16:19], v[48:51], a[224:227], a[16:19]
    v_exp_f32 v117, v117
    v_mfma_f32_16x16x32_bf16 a[16:19], v[52:55], a[228:231], a[16:19]
    ds_read_b128 a[188:191], v19 offset:45056
    v_cvt_pk_bf16_f32 v65, v114, v115
    v_mfma_f32_16x16x32_bf16 a[20:23], v[52:55], a[236:239], a[20:23]
    v_exp_f32 v118, v118
    v_mfma_f32_16x16x32_bf16 a[20:23], v[48:51], a[232:235], a[20:23]
    v_exp_f32 v119, v119
    v_mfma_f32_16x16x32_bf16 a[24:27], v[48:51], a[240:243], a[24:27]
    ds_read_b128 a[172:175], v19 offset:40960
    v_cvt_pk_bf16_f32 v66, v116, v117
    v_mfma_f32_16x16x32_bf16 a[24:27], v[52:55], a[244:247], a[24:27]
    v_exp_f32 v120, v120
    v_mfma_f32_16x16x32_bf16 a[28:31], v[52:55], a[252:255], a[28:31]
    v_exp_f32 v121, v121
    v_mfma_f32_16x16x32_bf16 a[28:31], v[48:51], a[248:251], a[28:31]
    ds_read_b128 a[168:171], v18 offset:40960
    v_cvt_pk_bf16_f32 v67, v118, v119
    v_smfmac_f32_16x16x64_bf16 v[220:223], v[216:219], v[48:55], v15
    v_exp_f32 v122, v122
    v_mfma_f32_16x16x32_bf16 a[60:63], v[56:59], a[248:251], a[60:63]
    v_exp_f32 v123, v123
    v_mfma_f32_16x16x32_bf16 a[60:63], v[60:63], a[252:255], a[60:63]
    ds_read_b128 a[164:167], v17 offset:40960
    v_cvt_pk_bf16_f32 v68, v120, v121
    v_mfma_f32_16x16x32_bf16 a[56:59], v[60:63], a[244:247], a[56:59]
    v_exp_f32 v124, v124
    v_mfma_f32_16x16x32_bf16 a[56:59], v[56:59], a[240:243], a[56:59]
    v_exp_f32 v125, v125
    v_mfma_f32_16x16x32_bf16 a[52:55], v[56:59], a[232:235], a[52:55]
    ds_read_b128 a[160:163], v16 offset:40960
    v_cvt_pk_bf16_f32 v69, v122, v123
    v_mfma_f32_16x16x32_bf16 a[52:55], v[60:63], a[236:239], a[52:55]
    v_exp_f32 v126, v126
    v_mfma_f32_16x16x32_bf16 a[48:51], v[60:63], a[228:231], a[48:51]
    v_exp_f32 v127, v127
    v_mfma_f32_16x16x32_bf16 a[48:51], v[56:59], a[224:227], a[48:51]
    ds_read_b128 a[144:147], v16 offset:36864
    v_cvt_pk_bf16_f32 v70, v124, v125
    v_mfma_f32_16x16x32_bf16 a[44:47], v[56:59], a[216:219], a[44:47]
    v_exp_f32 v140, v140
    v_mfma_f32_16x16x32_bf16 a[44:47], v[60:63], a[220:223], a[44:47]
    v_exp_f32 v141, v141
    v_mfma_f32_16x16x32_bf16 a[40:43], v[60:63], a[212:215], a[40:43]
    ds_read_b128 a[148:151], v17 offset:36864
    v_cvt_pk_bf16_f32 v71, v126, v127
    v_mfma_f32_16x16x32_bf16 a[40:43], v[56:59], a[208:211], a[40:43]
    v_exp_f32 v142, v142
    v_mfma_f32_16x16x32_bf16 a[36:39], v[56:59], a[200:203], a[36:39]
    v_exp_f32 v143, v143
    v_mfma_f32_16x16x32_bf16 a[36:39], v[60:63], a[204:207], a[36:39]
    ds_read_b128 a[152:155], v18 offset:36864
    v_cvt_pk_bf16_f32 v78, v140, v141
    v_mfma_f32_16x16x32_bf16 a[32:35], v[60:63], a[196:199], a[32:35]
    v_exp_f32 v136, v136
    v_mfma_f32_16x16x32_bf16 a[32:35], v[56:59], a[192:195], a[32:35]
    v_exp_f32 v137, v137
    v_smfmac_f32_16x16x64_bf16 v[224:227], v[216:219], v[56:63], v15
    ds_read_b128 a[156:159], v19 offset:36864
    v_cvt_pk_bf16_f32 v79, v142, v143
    v_mfma_f32_16x16x32_bf16 a[64:67], v[64:67], a[192:195], a[64:67]
    v_exp_f32 v138, v138
    v_mfma_f32_16x16x32_bf16 a[64:67], v[68:71], a[196:199], a[64:67]
    v_exp_f32 v139, v139
    v_mfma_f32_16x16x32_bf16 a[68:71], v[68:71], a[204:207], a[68:71]
    ds_read_b128 a[140:143], v19 offset:32768
    v_cvt_pk_bf16_f32 v76, v136, v137
    v_mfma_f32_16x16x32_bf16 a[68:71], v[64:67], a[200:203], a[68:71]
    v_exp_f32 v132, v132
    v_mfma_f32_16x16x32_bf16 a[72:75], v[64:67], a[208:211], a[72:75]
    v_exp_f32 v133, v133
    v_mfma_f32_16x16x32_bf16 a[72:75], v[68:71], a[212:215], a[72:75]
    ds_read_b128 a[136:139], v18 offset:32768
    v_cvt_pk_bf16_f32 v77, v138, v139
    v_mfma_f32_16x16x32_bf16 a[76:79], v[68:71], a[220:223], a[76:79]
    v_exp_f32 v134, v134
    v_mfma_f32_16x16x32_bf16 a[76:79], v[64:67], a[216:219], a[76:79]
    v_exp_f32 v135, v135
    v_mfma_f32_16x16x32_bf16 a[80:83], v[64:67], a[224:227], a[80:83]
    ds_read_b128 a[132:135], v17 offset:32768
    v_cvt_pk_bf16_f32 v74, v132, v133
    v_mfma_f32_16x16x32_bf16 a[80:83], v[68:71], a[228:231], a[80:83]
    v_exp_f32 v128, v128
    v_mfma_f32_16x16x32_bf16 a[84:87], v[68:71], a[236:239], a[84:87]
    v_exp_f32 v129, v129
    v_mfma_f32_16x16x32_bf16 a[84:87], v[64:67], a[232:235], a[84:87]
    ds_read_b128 a[128:131], v16 offset:32768
    v_cvt_pk_bf16_f32 v75, v134, v135
    v_mfma_f32_16x16x32_bf16 a[88:91], v[64:67], a[240:243], a[88:91]
    v_exp_f32 v130, v130
    v_mfma_f32_16x16x32_bf16 a[88:91], v[68:71], a[244:247], a[88:91]
    v_exp_f32 v131, v131
    v_mfma_f32_16x16x32_bf16 a[92:95], v[68:71], a[252:255], a[92:95]
    v_cvt_pk_bf16_f32 v72, v128, v129
    v_cvt_pk_bf16_f32 v73, v130, v131
    v_mfma_f32_16x16x32_bf16 a[92:95], v[64:67], a[248:251], a[92:95]
    s_add_u32 s4, s12, s30
    s_addc_u32 s5, s13, 0
    v_smfmac_f32_16x16x64_bf16 v[228:231], v[216:219], v[64:71], v15
    s_waitcnt vmcnt(8) lgkmcnt(0)
    s_barrier
    v_mfma_f32_16x16x32_bf16 a[124:127], v[72:75], a[248:251], a[124:127]
    v_mfma_f32_16x16x32_bf16 a[124:127], v[76:79], a[252:255], a[124:127]
    v_mfma_f32_16x16x32_bf16 a[120:123], v[76:79], a[244:247], a[120:123]
    v_mfma_f32_16x16x32_bf16 a[120:123], v[72:75], a[240:243], a[120:123]
    global_load_lds_dwordx4 v12, s[6:7]
    v_mfma_f32_16x16x32_bf16 a[116:119], v[72:75], a[232:235], a[116:119]
    ds_read_b64_tr_b16 a[248:249], v27 offset:32768
    v_mfma_f32_16x16x32_bf16 a[116:119], v[76:79], a[236:239], a[116:119]
    ds_read_b64_tr_b16 a[250:251], v27 offset:36864
    v_mfma_f32_16x16x32_bf16 a[112:115], v[76:79], a[228:231], a[112:115]
    ds_read_b64_tr_b16 a[252:253], v27 offset:40960
    v_mfma_f32_16x16x32_bf16 a[112:115], v[72:75], a[224:227], a[112:115]
    global_load_lds_dwordx4 v13, s[6:7] offset:1024
    v_mfma_f32_16x16x32_bf16 a[108:111], v[72:75], a[216:219], a[108:111]
    ds_read_b64_tr_b16 a[254:255], v27 offset:45056
    v_mfma_f32_16x16x32_bf16 a[108:111], v[76:79], a[220:223], a[108:111]
    ds_read_b64_tr_b16 a[240:241], v26 offset:32768
    v_mfma_f32_16x16x32_bf16 a[104:107], v[76:79], a[212:215], a[104:107]
    ds_read_b64_tr_b16 a[242:243], v26 offset:36864
    v_mfma_f32_16x16x32_bf16 a[104:107], v[72:75], a[208:211], a[104:107]
    global_load_lds_dwordx4 v12, s[6:7] offset:2048
    v_mfma_f32_16x16x32_bf16 a[100:103], v[72:75], a[200:203], a[100:103]
    ds_read_b64_tr_b16 a[244:245], v26 offset:40960
    v_mfma_f32_16x16x32_bf16 a[100:103], v[76:79], a[204:207], a[100:103]
    ds_read_b64_tr_b16 a[246:247], v26 offset:45056
    v_mfma_f32_16x16x32_bf16 a[96:99], v[76:79], a[196:199], a[96:99]
    ds_read_b64_tr_b16 a[232:233], v25 offset:32768
    v_mfma_f32_16x16x32_bf16 a[96:99], v[72:75], a[192:195], a[96:99]
    global_load_lds_dwordx4 v13, s[6:7] offset:3072
    v_smfmac_f32_16x16x64_bf16 v[232:235], v[216:219], v[72:79], v15
    s_mov_b32 m0, s98
    v_mfma_f32_16x16x32_bf16 v[80:83], a[128:131], v[144:147], v[32:35]
    ds_read_b64_tr_b16 a[234:235], v25 offset:36864
    v_mfma_f32_16x16x32_bf16 v[80:83], a[132:135], v[148:151], v[80:83]
    ds_read_b64_tr_b16 a[236:237], v25 offset:40960
    v_mfma_f32_16x16x32_bf16 v[80:83], a[136:139], v[152:155], v[80:83]
    ds_read_b64_tr_b16 a[238:239], v25 offset:45056
    v_mfma_f32_16x16x32_bf16 v[80:83], a[140:143], v[156:159], v[80:83]
    global_load_lds_dwordx4 v12, s[4:5]
    v_mfma_f32_16x16x32_bf16 v[84:87], a[156:159], v[156:159], v[32:35]
    ds_read_b64_tr_b16 a[224:225], v24 offset:32768
    v_mfma_f32_16x16x32_bf16 v[84:87], a[152:155], v[152:155], v[84:87]
    ds_read_b64_tr_b16 a[226:227], v24 offset:36864
    v_mfma_f32_16x16x32_bf16 v[84:87], a[148:151], v[148:151], v[84:87]
    ds_read_b64_tr_b16 a[228:229], v24 offset:40960
    v_mfma_f32_16x16x32_bf16 v[84:87], a[144:147], v[144:147], v[84:87]
    global_load_lds_dwordx4 v13, s[4:5] offset:1024
    v_mfma_f32_16x16x32_bf16 v[88:91], a[160:163], v[144:147], v[32:35]
    ds_read_b64_tr_b16 a[230:231], v24 offset:45056
    v_mfma_f32_16x16x32_bf16 v[88:91], a[164:167], v[148:151], v[88:91]
    ds_read_b64_tr_b16 a[216:217], v23 offset:32768
    v_mfma_f32_16x16x32_bf16 v[88:91], a[168:171], v[152:155], v[88:91]
    ds_read_b64_tr_b16 a[218:219], v23 offset:36864
    v_mfma_f32_16x16x32_bf16 v[88:91], a[172:175], v[156:159], v[88:91]
    global_load_lds_dwordx4 v12, s[4:5] offset:2048
    v_mfma_f32_16x16x32_bf16 v[92:95], a[188:191], v[156:159], v[32:35]
    ds_read_b64_tr_b16 a[220:221], v23 offset:40960
    v_mfma_f32_16x16x32_bf16 v[92:95], a[184:187], v[152:155], v[92:95]
    ds_read_b64_tr_b16 a[222:223], v23 offset:45056
    v_mfma_f32_16x16x32_bf16 v[92:95], a[180:183], v[148:151], v[92:95]
    ds_read_b64_tr_b16 a[208:209], v22 offset:32768
    v_mfma_f32_16x16x32_bf16 v[92:95], a[176:179], v[144:147], v[92:95]
    global_load_lds_dwordx4 v13, s[4:5] offset:3072
    v_mfma_f32_16x16x32_bf16 v[108:111], a[176:179], v[160:163], v[36:39]
    ds_read_b64_tr_b16 a[210:211], v22 offset:36864
    v_mfma_f32_16x16x32_bf16 v[108:111], a[180:183], v[164:167], v[108:111]
    v_exp_f32 v80, v80
    v_mfma_f32_16x16x32_bf16 v[108:111], a[184:187], v[168:171], v[108:111]
    v_exp_f32 v81, v81
    v_mfma_f32_16x16x32_bf16 v[108:111], a[188:191], v[172:175], v[108:111]
    ds_read_b64_tr_b16 a[212:213], v22 offset:40960
    s_mov_b32 m0, s101
    v_mfma_f32_16x16x32_bf16 v[104:107], a[172:175], v[172:175], v[36:39]
    v_exp_f32 v82, v82
    v_mfma_f32_16x16x32_bf16 v[104:107], a[168:171], v[168:171], v[104:107]
    v_exp_f32 v83, v83
    v_mfma_f32_16x16x32_bf16 v[104:107], a[164:167], v[164:167], v[104:107]
    ds_read_b64_tr_b16 a[214:215], v22 offset:45056
    v_cvt_pk_bf16_f32 v48, v80, v81
    v_mfma_f32_16x16x32_bf16 v[104:107], a[160:163], v[160:163], v[104:107]
    v_exp_f32 v84, v84
    v_mfma_f32_16x16x32_bf16 v[100:103], a[144:147], v[160:163], v[36:39]
    v_exp_f32 v85, v85
    v_mfma_f32_16x16x32_bf16 v[100:103], a[148:151], v[164:167], v[100:103]
    ds_read_b64_tr_b16 a[200:201], v21 offset:32768
    v_cvt_pk_bf16_f32 v49, v82, v83
    v_mfma_f32_16x16x32_bf16 v[100:103], a[152:155], v[168:171], v[100:103]
    v_exp_f32 v86, v86
    v_mfma_f32_16x16x32_bf16 v[100:103], a[156:159], v[172:175], v[100:103]
    v_exp_f32 v87, v87
    v_mfma_f32_16x16x32_bf16 v[96:99], a[140:143], v[172:175], v[36:39]
    ds_read_b64_tr_b16 a[202:203], v21 offset:36864
    v_cvt_pk_bf16_f32 v50, v84, v85
    v_mfma_f32_16x16x32_bf16 v[96:99], a[136:139], v[168:171], v[96:99]
    v_exp_f32 v88, v88
    v_mfma_f32_16x16x32_bf16 v[96:99], a[132:135], v[164:167], v[96:99]
    v_exp_f32 v89, v89
    v_mfma_f32_16x16x32_bf16 v[96:99], a[128:131], v[160:163], v[96:99]
    ds_read_b64_tr_b16 a[204:205], v21 offset:40960
    v_cvt_pk_bf16_f32 v51, v86, v87
    v_mfma_f32_16x16x32_bf16 v[112:115], a[128:131], v[176:179], v[40:43]
    v_exp_f32 v90, v90
    v_mfma_f32_16x16x32_bf16 v[112:115], a[132:135], v[180:183], v[112:115]
    v_exp_f32 v91, v91
    v_mfma_f32_16x16x32_bf16 v[112:115], a[136:139], v[184:187], v[112:115]
    ds_read_b64_tr_b16 a[206:207], v21 offset:45056
    v_cvt_pk_bf16_f32 v52, v88, v89
    v_mfma_f32_16x16x32_bf16 v[112:115], a[140:143], v[188:191], v[112:115]
    v_exp_f32 v92, v92
    v_mfma_f32_16x16x32_bf16 v[116:119], a[156:159], v[188:191], v[40:43]
    v_exp_f32 v93, v93
    v_mfma_f32_16x16x32_bf16 v[116:119], a[152:155], v[184:187], v[116:119]
    ds_read_b64_tr_b16 a[192:193], v20 offset:32768
    v_cvt_pk_bf16_f32 v53, v90, v91
    v_mfma_f32_16x16x32_bf16 v[116:119], a[148:151], v[180:183], v[116:119]
    v_exp_f32 v94, v94
    v_mfma_f32_16x16x32_bf16 v[116:119], a[144:147], v[176:179], v[116:119]
    v_exp_f32 v95, v95
    v_mfma_f32_16x16x32_bf16 v[120:123], a[160:163], v[176:179], v[40:43]
    ds_read_b64_tr_b16 a[194:195], v20 offset:36864
    v_cvt_pk_bf16_f32 v54, v92, v93
    v_mfma_f32_16x16x32_bf16 v[120:123], a[164:167], v[180:183], v[120:123]
    v_exp_f32 v108, v108
    v_mfma_f32_16x16x32_bf16 v[120:123], a[168:171], v[184:187], v[120:123]
    v_exp_f32 v109, v109
    v_mfma_f32_16x16x32_bf16 v[120:123], a[172:175], v[188:191], v[120:123]
    ds_read_b64_tr_b16 a[196:197], v20 offset:40960
    v_cvt_pk_bf16_f32 v55, v94, v95
    v_mfma_f32_16x16x32_bf16 v[124:127], a[188:191], v[188:191], v[40:43]
    v_exp_f32 v110, v110
    v_mfma_f32_16x16x32_bf16 v[124:127], a[184:187], v[184:187], v[124:127]
    v_exp_f32 v111, v111
    v_mfma_f32_16x16x32_bf16 v[124:127], a[180:183], v[180:183], v[124:127]
    ds_read_b64_tr_b16 a[198:199], v20 offset:45056
    v_cvt_pk_bf16_f32 v62, v108, v109
    v_mfma_f32_16x16x32_bf16 v[124:127], a[176:179], v[176:179], v[124:127]
    v_exp_f32 v104, v104
    v_mfma_f32_16x16x32_bf16 v[140:143], a[176:179], v[192:195], v[44:47]
    v_exp_f32 v105, v105
    v_mfma_f32_16x16x32_bf16 v[140:143], a[180:183], v[196:199], v[140:143]
    s_add_u32 s6, s16, s30
    v_cvt_pk_bf16_f32 v63, v110, v111
    v_mfma_f32_16x16x32_bf16 v[140:143], a[184:187], v[200:203], v[140:143]
    v_exp_f32 v106, v106
    v_mfma_f32_16x16x32_bf16 v[140:143], a[188:191], v[204:207], v[140:143]
    v_exp_f32 v107, v107
    v_mfma_f32_16x16x32_bf16 v[136:139], a[172:175], v[204:207], v[44:47]
    s_addc_u32 s7, s17, 0
    v_cvt_pk_bf16_f32 v60, v104, v105
    v_mfma_f32_16x16x32_bf16 v[136:139], a[168:171], v[200:203], v[136:139]
    v_exp_f32 v100, v100
    v_mfma_f32_16x16x32_bf16 v[136:139], a[164:167], v[196:199], v[136:139]
    v_exp_f32 v101, v101
    v_mfma_f32_16x16x32_bf16 v[136:139], a[160:163], v[192:195], v[136:139]
    s_add_u32 s30, s30, 16384
    v_cvt_pk_bf16_f32 v61, v106, v107
    v_mfma_f32_16x16x32_bf16 v[132:135], a[144:147], v[192:195], v[44:47]
    v_exp_f32 v102, v102
    v_mfma_f32_16x16x32_bf16 v[132:135], a[148:151], v[196:199], v[132:135]
    v_exp_f32 v103, v103
    v_mfma_f32_16x16x32_bf16 v[132:135], a[152:155], v[200:203], v[132:135]
    s_and_b32 s30, s30, 0x7ffff
    v_cvt_pk_bf16_f32 v58, v100, v101
    v_mfma_f32_16x16x32_bf16 v[132:135], a[156:159], v[204:207], v[132:135]
    v_exp_f32 v96, v96
    v_mfma_f32_16x16x32_bf16 v[128:131], a[140:143], v[204:207], v[44:47]
    v_exp_f32 v97, v97
    v_mfma_f32_16x16x32_bf16 v[128:131], a[136:139], v[200:203], v[128:131]
    v_cvt_pk_bf16_f32 v59, v102, v103
    s_waitcnt lgkmcnt(0)
    v_mfma_f32_16x16x32_bf16 v[128:131], a[132:135], v[196:199], v[128:131]
    v_exp_f32 v98, v98
    v_mfma_f32_16x16x32_bf16 v[128:131], a[128:131], v[192:195], v[128:131]
    v_exp_f32 v99, v99
    v_mfma_f32_16x16x32_bf16 a[0:3], v[48:51], a[192:195], a[0:3]
    ds_read_b128 a[176:179], v16 offset:12288
    v_cvt_pk_bf16_f32 v56, v96, v97
    v_mfma_f32_16x16x32_bf16 a[0:3], v[52:55], a[196:199], a[0:3]
    v_exp_f32 v112, v112
    v_mfma_f32_16x16x32_bf16 a[4:7], v[52:55], a[204:207], a[4:7]
    v_exp_f32 v113, v113
    v_mfma_f32_16x16x32_bf16 a[4:7], v[48:51], a[200:203], a[4:7]
    ds_read_b128 a[180:183], v17 offset:12288
    v_cvt_pk_bf16_f32 v57, v98, v99
    v_mfma_f32_16x16x32_bf16 a[8:11], v[48:51], a[208:211], a[8:11]
    v_exp_f32 v114, v114
    v_mfma_f32_16x16x32_bf16 a[8:11], v[52:55], a[212:215], a[8:11]
    v_exp_f32 v115, v115
    v_mfma_f32_16x16x32_bf16 a[12:15], v[52:55], a[220:223], a[12:15]
    ds_read_b128 a[184:187], v18 offset:12288
    v_cvt_pk_bf16_f32 v64, v112, v113
    v_mfma_f32_16x16x32_bf16 a[12:15], v[48:51], a[216:219], a[12:15]
    v_exp_f32 v116, v116
    v_mfma_f32_16x16x32_bf16 a[16:19], v[48:51], a[224:227], a[16:19]
    v_exp_f32 v117, v117
    v_mfma_f32_16x16x32_bf16 a[16:19], v[52:55], a[228:231], a[16:19]
    ds_read_b128 a[188:191], v19 offset:12288
    v_cvt_pk_bf16_f32 v65, v114, v115
    v_mfma_f32_16x16x32_bf16 a[20:23], v[52:55], a[236:239], a[20:23]
    v_exp_f32 v118, v118
    v_mfma_f32_16x16x32_bf16 a[20:23], v[48:51], a[232:235], a[20:23]
    v_exp_f32 v119, v119
    v_mfma_f32_16x16x32_bf16 a[24:27], v[48:51], a[240:243], a[24:27]
    ds_read_b128 a[172:175], v19 offset:8192
    v_cvt_pk_bf16_f32 v66, v116, v117
    v_mfma_f32_16x16x32_bf16 a[24:27], v[52:55], a[244:247], a[24:27]
    v_exp_f32 v120, v120
    v_mfma_f32_16x16x32_bf16 a[28:31], v[52:55], a[252:255], a[28:31]
    v_exp_f32 v121, v121
    v_mfma_f32_16x16x32_bf16 a[28:31], v[48:51], a[248:251], a[28:31]
    ds_read_b128 a[168:171], v18 offset:8192
    v_cvt_pk_bf16_f32 v67, v118, v119
    v_smfmac_f32_16x16x64_bf16 v[220:223], v[216:219], v[48:55], v15
    v_exp_f32 v122, v122
    v_mfma_f32_16x16x32_bf16 a[60:63], v[56:59], a[248:251], a[60:63]
    v_exp_f32 v123, v123
    v_mfma_f32_16x16x32_bf16 a[60:63], v[60:63], a[252:255], a[60:63]
    ds_read_b128 a[164:167], v17 offset:8192
    v_cvt_pk_bf16_f32 v68, v120, v121
    v_mfma_f32_16x16x32_bf16 a[56:59], v[60:63], a[244:247], a[56:59]
    v_exp_f32 v124, v124
    v_mfma_f32_16x16x32_bf16 a[56:59], v[56:59], a[240:243], a[56:59]
    v_exp_f32 v125, v125
    v_mfma_f32_16x16x32_bf16 a[52:55], v[56:59], a[232:235], a[52:55]
    ds_read_b128 a[160:163], v16 offset:8192
    v_cvt_pk_bf16_f32 v69, v122, v123
    v_mfma_f32_16x16x32_bf16 a[52:55], v[60:63], a[236:239], a[52:55]
    v_exp_f32 v126, v126
    v_mfma_f32_16x16x32_bf16 a[48:51], v[60:63], a[228:231], a[48:51]
    v_exp_f32 v127, v127
    v_mfma_f32_16x16x32_bf16 a[48:51], v[56:59], a[224:227], a[48:51]
    ds_read_b128 a[144:147], v16 offset:4096
    v_cvt_pk_bf16_f32 v70, v124, v125
    v_mfma_f32_16x16x32_bf16 a[44:47], v[56:59], a[216:219], a[44:47]
    v_exp_f32 v140, v140
    v_mfma_f32_16x16x32_bf16 a[44:47], v[60:63], a[220:223], a[44:47]
    v_exp_f32 v141, v141
    v_mfma_f32_16x16x32_bf16 a[40:43], v[60:63], a[212:215], a[40:43]
    ds_read_b128 a[148:151], v17 offset:4096
    v_cvt_pk_bf16_f32 v71, v126, v127
    v_mfma_f32_16x16x32_bf16 a[40:43], v[56:59], a[208:211], a[40:43]
    v_exp_f32 v142, v142
    v_mfma_f32_16x16x32_bf16 a[36:39], v[56:59], a[200:203], a[36:39]
    v_exp_f32 v143, v143
    v_mfma_f32_16x16x32_bf16 a[36:39], v[60:63], a[204:207], a[36:39]
    ds_read_b128 a[152:155], v18 offset:4096
    v_cvt_pk_bf16_f32 v78, v140, v141
    v_mfma_f32_16x16x32_bf16 a[32:35], v[60:63], a[196:199], a[32:35]
    v_exp_f32 v136, v136
    v_mfma_f32_16x16x32_bf16 a[32:35], v[56:59], a[192:195], a[32:35]
    v_exp_f32 v137, v137
    v_smfmac_f32_16x16x64_bf16 v[224:227], v[216:219], v[56:63], v15
    ds_read_b128 a[156:159], v19 offset:4096
    v_cvt_pk_bf16_f32 v79, v142, v143
    v_mfma_f32_16x16x32_bf16 a[64:67], v[64:67], a[192:195], a[64:67]
    v_exp_f32 v138, v138
    v_mfma_f32_16x16x32_bf16 a[64:67], v[68:71], a[196:199], a[64:67]
    v_exp_f32 v139, v139
    v_mfma_f32_16x16x32_bf16 a[68:71], v[68:71], a[204:207], a[68:71]
    ds_read_b128 a[140:143], v19 offset:0
    v_cvt_pk_bf16_f32 v76, v136, v137
    v_mfma_f32_16x16x32_bf16 a[68:71], v[64:67], a[200:203], a[68:71]
    v_exp_f32 v132, v132
    v_mfma_f32_16x16x32_bf16 a[72:75], v[64:67], a[208:211], a[72:75]
    v_exp_f32 v133, v133
    v_mfma_f32_16x16x32_bf16 a[72:75], v[68:71], a[212:215], a[72:75]
    ds_read_b128 a[136:139], v18 offset:0
    v_cvt_pk_bf16_f32 v77, v138, v139
    v_mfma_f32_16x16x32_bf16 a[76:79], v[68:71], a[220:223], a[76:79]
    v_exp_f32 v134, v134
    v_mfma_f32_16x16x32_bf16 a[76:79], v[64:67], a[216:219], a[76:79]
    v_exp_f32 v135, v135
    v_mfma_f32_16x16x32_bf16 a[80:83], v[64:67], a[224:227], a[80:83]
    ds_read_b128 a[132:135], v17 offset:0
    v_cvt_pk_bf16_f32 v74, v132, v133
    v_mfma_f32_16x16x32_bf16 a[80:83], v[68:71], a[228:231], a[80:83]
    v_exp_f32 v128, v128
    v_mfma_f32_16x16x32_bf16 a[84:87], v[68:71], a[236:239], a[84:87]
    v_exp_f32 v129, v129
    v_mfma_f32_16x16x32_bf16 a[84:87], v[64:67], a[232:235], a[84:87]
    ds_read_b128 a[128:131], v16 offset:0
    v_cvt_pk_bf16_f32 v75, v134, v135
    v_mfma_f32_16x16x32_bf16 a[88:91], v[64:67], a[240:243], a[88:91]
    v_exp_f32 v130, v130
    v_mfma_f32_16x16x32_bf16 a[88:91], v[68:71], a[244:247], a[88:91]
    v_exp_f32 v131, v131
    v_mfma_f32_16x16x32_bf16 a[92:95], v[68:71], a[252:255], a[92:95]
    v_cvt_pk_bf16_f32 v72, v128, v129
    v_cvt_pk_bf16_f32 v73, v130, v131
    v_mfma_f32_16x16x32_bf16 a[92:95], v[64:67], a[248:251], a[92:95]
    s_add_u32 s4, s12, s30
    s_addc_u32 s5, s13, 0
    v_smfmac_f32_16x16x64_bf16 v[228:231], v[216:219], v[64:71], v15
    s_waitcnt vmcnt(8) lgkmcnt(0)
    s_barrier
    v_mfma_f32_16x16x32_bf16 a[124:127], v[72:75], a[248:251], a[124:127]
    v_mfma_f32_16x16x32_bf16 a[124:127], v[76:79], a[252:255], a[124:127]
    v_mfma_f32_16x16x32_bf16 a[120:123], v[76:79], a[244:247], a[120:123]
    v_mfma_f32_16x16x32_bf16 a[120:123], v[72:75], a[240:243], a[120:123]
    global_load_lds_dwordx4 v12, s[6:7]
    v_mfma_f32_16x16x32_bf16 a[116:119], v[72:75], a[232:235], a[116:119]
    ds_read_b64_tr_b16 a[248:249], v27 offset:0
    v_mfma_f32_16x16x32_bf16 a[116:119], v[76:79], a[236:239], a[116:119]
    ds_read_b64_tr_b16 a[250:251], v27 offset:4096
    v_mfma_f32_16x16x32_bf16 a[112:115], v[76:79], a[228:231], a[112:115]
    ds_read_b64_tr_b16 a[252:253], v27 offset:8192
    v_mfma_f32_16x16x32_bf16 a[112:115], v[72:75], a[224:227], a[112:115]
    global_load_lds_dwordx4 v13, s[6:7] offset:1024
    v_mfma_f32_16x16x32_bf16 a[108:111], v[72:75], a[216:219], a[108:111]
    ds_read_b64_tr_b16 a[254:255], v27 offset:12288
    v_mfma_f32_16x16x32_bf16 a[108:111], v[76:79], a[220:223], a[108:111]
    ds_read_b64_tr_b16 a[240:241], v26 offset:0
    v_mfma_f32_16x16x32_bf16 a[104:107], v[76:79], a[212:215], a[104:107]
    ds_read_b64_tr_b16 a[242:243], v26 offset:4096
    v_mfma_f32_16x16x32_bf16 a[104:107], v[72:75], a[208:211], a[104:107]
    global_load_lds_dwordx4 v12, s[6:7] offset:2048
    v_mfma_f32_16x16x32_bf16 a[100:103], v[72:75], a[200:203], a[100:103]
    ds_read_b64_tr_b16 a[244:245], v26 offset:8192
    v_mfma_f32_16x16x32_bf16 a[100:103], v[76:79], a[204:207], a[100:103]
    ds_read_b64_tr_b16 a[246:247], v26 offset:12288
    v_mfma_f32_16x16x32_bf16 a[96:99], v[76:79], a[196:199], a[96:99]
    ds_read_b64_tr_b16 a[232:233], v25 offset:0
    v_mfma_f32_16x16x32_bf16 a[96:99], v[72:75], a[192:195], a[96:99]
    global_load_lds_dwordx4 v13, s[6:7] offset:3072
    v_smfmac_f32_16x16x64_bf16 v[232:235], v[216:219], v[72:79], v15
    s_mov_b32 m0, s96
    v_mfma_f32_16x16x32_bf16 v[80:83], a[128:131], v[144:147], v[32:35]
    ds_read_b64_tr_b16 a[234:235], v25 offset:4096
    v_mfma_f32_16x16x32_bf16 v[80:83], a[132:135], v[148:151], v[80:83]
    ds_read_b64_tr_b16 a[236:237], v25 offset:8192
    v_mfma_f32_16x16x32_bf16 v[80:83], a[136:139], v[152:155], v[80:83]
    ds_read_b64_tr_b16 a[238:239], v25 offset:12288
    v_mfma_f32_16x16x32_bf16 v[80:83], a[140:143], v[156:159], v[80:83]
    global_load_lds_dwordx4 v12, s[4:5]
    v_mfma_f32_16x16x32_bf16 v[84:87], a[156:159], v[156:159], v[32:35]
    ds_read_b64_tr_b16 a[224:225], v24 offset:0
    v_mfma_f32_16x16x32_bf16 v[84:87], a[152:155], v[152:155], v[84:87]
    ds_read_b64_tr_b16 a[226:227], v24 offset:4096
    v_mfma_f32_16x16x32_bf16 v[84:87], a[148:151], v[148:151], v[84:87]
    ds_read_b64_tr_b16 a[228:229], v24 offset:8192
    v_mfma_f32_16x16x32_bf16 v[84:87], a[144:147], v[144:147], v[84:87]
    global_load_lds_dwordx4 v13, s[4:5] offset:1024
    v_mfma_f32_16x16x32_bf16 v[88:91], a[160:163], v[144:147], v[32:35]
    ds_read_b64_tr_b16 a[230:231], v24 offset:12288
    v_mfma_f32_16x16x32_bf16 v[88:91], a[164:167], v[148:151], v[88:91]
    ds_read_b64_tr_b16 a[216:217], v23 offset:0
    v_mfma_f32_16x16x32_bf16 v[88:91], a[168:171], v[152:155], v[88:91]
    ds_read_b64_tr_b16 a[218:219], v23 offset:4096
    v_mfma_f32_16x16x32_bf16 v[88:91], a[172:175], v[156:159], v[88:91]
    global_load_lds_dwordx4 v12, s[4:5] offset:2048
    v_mfma_f32_16x16x32_bf16 v[92:95], a[188:191], v[156:159], v[32:35]
    ds_read_b64_tr_b16 a[220:221], v23 offset:8192
    v_mfma_f32_16x16x32_bf16 v[92:95], a[184:187], v[152:155], v[92:95]
    ds_read_b64_tr_b16 a[222:223], v23 offset:12288
    v_mfma_f32_16x16x32_bf16 v[92:95], a[180:183], v[148:151], v[92:95]
    ds_read_b64_tr_b16 a[208:209], v22 offset:0
    v_mfma_f32_16x16x32_bf16 v[92:95], a[176:179], v[144:147], v[92:95]
    global_load_lds_dwordx4 v13, s[4:5] offset:3072
    v_mfma_f32_16x16x32_bf16 v[108:111], a[176:179], v[160:163], v[36:39]
    ds_read_b64_tr_b16 a[210:211], v22 offset:4096
    v_mfma_f32_16x16x32_bf16 v[108:111], a[180:183], v[164:167], v[108:111]
    v_exp_f32 v80, v80
    v_mfma_f32_16x16x32_bf16 v[108:111], a[184:187], v[168:171], v[108:111]
    v_exp_f32 v81, v81
    v_mfma_f32_16x16x32_bf16 v[108:111], a[188:191], v[172:175], v[108:111]
    ds_read_b64_tr_b16 a[212:213], v22 offset:8192
    s_mov_b32 m0, s99
    v_mfma_f32_16x16x32_bf16 v[104:107], a[172:175], v[172:175], v[36:39]
    v_exp_f32 v82, v82
    v_mfma_f32_16x16x32_bf16 v[104:107], a[168:171], v[168:171], v[104:107]
    v_exp_f32 v83, v83
    v_mfma_f32_16x16x32_bf16 v[104:107], a[164:167], v[164:167], v[104:107]
    ds_read_b64_tr_b16 a[214:215], v22 offset:12288
    v_cvt_pk_bf16_f32 v48, v80, v81
    v_mfma_f32_16x16x32_bf16 v[104:107], a[160:163], v[160:163], v[104:107]
    v_exp_f32 v84, v84
    v_mfma_f32_16x16x32_bf16 v[100:103], a[144:147], v[160:163], v[36:39]
    v_exp_f32 v85, v85
    v_mfma_f32_16x16x32_bf16 v[100:103], a[148:151], v[164:167], v[100:103]
    ds_read_b64_tr_b16 a[200:201], v21 offset:0
    v_cvt_pk_bf16_f32 v49, v82, v83
    v_mfma_f32_16x16x32_bf16 v[100:103], a[152:155], v[168:171], v[100:103]
    v_exp_f32 v86, v86
    v_mfma_f32_16x16x32_bf16 v[100:103], a[156:159], v[172:175], v[100:103]
    v_exp_f32 v87, v87
    v_mfma_f32_16x16x32_bf16 v[96:99], a[140:143], v[172:175], v[36:39]
    ds_read_b64_tr_b16 a[202:203], v21 offset:4096
    v_cvt_pk_bf16_f32 v50, v84, v85
    v_mfma_f32_16x16x32_bf16 v[96:99], a[136:139], v[168:171], v[96:99]
    v_exp_f32 v88, v88
    v_mfma_f32_16x16x32_bf16 v[96:99], a[132:135], v[164:167], v[96:99]
    v_exp_f32 v89, v89
    v_mfma_f32_16x16x32_bf16 v[96:99], a[128:131], v[160:163], v[96:99]
    ds_read_b64_tr_b16 a[204:205], v21 offset:8192
    v_cvt_pk_bf16_f32 v51, v86, v87
    v_mfma_f32_16x16x32_bf16 v[112:115], a[128:131], v[176:179], v[40:43]
    v_exp_f32 v90, v90
    v_mfma_f32_16x16x32_bf16 v[112:115], a[132:135], v[180:183], v[112:115]
    v_exp_f32 v91, v91
    v_mfma_f32_16x16x32_bf16 v[112:115], a[136:139], v[184:187], v[112:115]
    ds_read_b64_tr_b16 a[206:207], v21 offset:12288
    v_cvt_pk_bf16_f32 v52, v88, v89
    v_mfma_f32_16x16x32_bf16 v[112:115], a[140:143], v[188:191], v[112:115]
    v_exp_f32 v92, v92
    v_mfma_f32_16x16x32_bf16 v[116:119], a[156:159], v[188:191], v[40:43]
    v_exp_f32 v93, v93
    v_mfma_f32_16x16x32_bf16 v[116:119], a[152:155], v[184:187], v[116:119]
    ds_read_b64_tr_b16 a[192:193], v20 offset:0
    v_cvt_pk_bf16_f32 v53, v90, v91
    v_mfma_f32_16x16x32_bf16 v[116:119], a[148:151], v[180:183], v[116:119]
    v_exp_f32 v94, v94
    v_mfma_f32_16x16x32_bf16 v[116:119], a[144:147], v[176:179], v[116:119]
    v_exp_f32 v95, v95
    v_mfma_f32_16x16x32_bf16 v[120:123], a[160:163], v[176:179], v[40:43]
    ds_read_b64_tr_b16 a[194:195], v20 offset:4096
    v_cvt_pk_bf16_f32 v54, v92, v93
    v_mfma_f32_16x16x32_bf16 v[120:123], a[164:167], v[180:183], v[120:123]
    v_exp_f32 v108, v108
    v_mfma_f32_16x16x32_bf16 v[120:123], a[168:171], v[184:187], v[120:123]
    v_exp_f32 v109, v109
    v_mfma_f32_16x16x32_bf16 v[120:123], a[172:175], v[188:191], v[120:123]
    ds_read_b64_tr_b16 a[196:197], v20 offset:8192
    v_cvt_pk_bf16_f32 v55, v94, v95
    v_mfma_f32_16x16x32_bf16 v[124:127], a[188:191], v[188:191], v[40:43]
    v_exp_f32 v110, v110
    v_mfma_f32_16x16x32_bf16 v[124:127], a[184:187], v[184:187], v[124:127]
    v_exp_f32 v111, v111
    v_mfma_f32_16x16x32_bf16 v[124:127], a[180:183], v[180:183], v[124:127]
    ds_read_b64_tr_b16 a[198:199], v20 offset:12288
    v_cvt_pk_bf16_f32 v62, v108, v109
    v_mfma_f32_16x16x32_bf16 v[124:127], a[176:179], v[176:179], v[124:127]
    v_exp_f32 v104, v104
    v_mfma_f32_16x16x32_bf16 v[140:143], a[176:179], v[192:195], v[44:47]
    v_exp_f32 v105, v105
    v_mfma_f32_16x16x32_bf16 v[140:143], a[180:183], v[196:199], v[140:143]
    s_add_u32 s6, s16, s30
    v_cvt_pk_bf16_f32 v63, v110, v111
    v_mfma_f32_16x16x32_bf16 v[140:143], a[184:187], v[200:203], v[140:143]
    v_exp_f32 v106, v106
    v_mfma_f32_16x16x32_bf16 v[140:143], a[188:191], v[204:207], v[140:143]
    v_exp_f32 v107, v107
    v_mfma_f32_16x16x32_bf16 v[136:139], a[172:175], v[204:207], v[44:47]
    s_addc_u32 s7, s17, 0
    v_cvt_pk_bf16_f32 v60, v104, v105
    v_mfma_f32_16x16x32_bf16 v[136:139], a[168:171], v[200:203], v[136:139]
    v_exp_f32 v100, v100
    v_mfma_f32_16x16x32_bf16 v[136:139], a[164:167], v[196:199], v[136:139]
    v_exp_f32 v101, v101
    v_mfma_f32_16x16x32_bf16 v[136:139], a[160:163], v[192:195], v[136:139]
    s_add_u32 s30, s30, 16384
    v_cvt_pk_bf16_f32 v61, v106, v107
    v_mfma_f32_16x16x32_bf16 v[132:135], a[144:147], v[192:195], v[44:47]
    v_exp_f32 v102, v102
    v_mfma_f32_16x16x32_bf16 v[132:135], a[148:151], v[196:199], v[132:135]
    v_exp_f32 v103, v103
    v_mfma_f32_16x16x32_bf16 v[132:135], a[152:155], v[200:203], v[132:135]
    s_and_b32 s30, s30, 0x7ffff
    v_cvt_pk_bf16_f32 v58, v100, v101
    v_mfma_f32_16x16x32_bf16 v[132:135], a[156:159], v[204:207], v[132:135]
    v_exp_f32 v96, v96
    v_mfma_f32_16x16x32_bf16 v[128:131], a[140:143], v[204:207], v[44:47]
    v_exp_f32 v97, v97
    v_mfma_f32_16x16x32_bf16 v[128:131], a[136:139], v[200:203], v[128:131]
    v_cvt_pk_bf16_f32 v59, v102, v103
    s_waitcnt lgkmcnt(0)
    v_mfma_f32_16x16x32_bf16 v[128:131], a[132:135], v[196:199], v[128:131]
    v_exp_f32 v98, v98
    v_mfma_f32_16x16x32_bf16 v[128:131], a[128:131], v[192:195], v[128:131]
    v_exp_f32 v99, v99
    v_mfma_f32_16x16x32_bf16 a[0:3], v[48:51], a[192:195], a[0:3]
    ds_read_b128 a[176:179], v16 offset:28672
    v_cvt_pk_bf16_f32 v56, v96, v97
    v_mfma_f32_16x16x32_bf16 a[0:3], v[52:55], a[196:199], a[0:3]
    v_exp_f32 v112, v112
    v_mfma_f32_16x16x32_bf16 a[4:7], v[52:55], a[204:207], a[4:7]
    v_exp_f32 v113, v113
    v_mfma_f32_16x16x32_bf16 a[4:7], v[48:51], a[200:203], a[4:7]
    ds_read_b128 a[180:183], v17 offset:28672
    v_cvt_pk_bf16_f32 v57, v98, v99
    v_mfma_f32_16x16x32_bf16 a[8:11], v[48:51], a[208:211], a[8:11]
    v_exp_f32 v114, v114
    v_mfma_f32_16x16x32_bf16 a[8:11], v[52:55], a[212:215], a[8:11]
    v_exp_f32 v115, v115
    v_mfma_f32_16x16x32_bf16 a[12:15], v[52:55], a[220:223], a[12:15]
    ds_read_b128 a[184:187], v18 offset:28672
    v_cvt_pk_bf16_f32 v64, v112, v113
    v_mfma_f32_16x16x32_bf16 a[12:15], v[48:51], a[216:219], a[12:15]
    v_exp_f32 v116, v116
    v_mfma_f32_16x16x32_bf16 a[16:19], v[48:51], a[224:227], a[16:19]
    v_exp_f32 v117, v117
    v_mfma_f32_16x16x32_bf16 a[16:19], v[52:55], a[228:231], a[16:19]
    ds_read_b128 a[188:191], v19 offset:28672
    v_cvt_pk_bf16_f32 v65, v114, v115
    v_mfma_f32_16x16x32_bf16 a[20:23], v[52:55], a[236:239], a[20:23]
    v_exp_f32 v118, v118
    v_mfma_f32_16x16x32_bf16 a[20:23], v[48:51], a[232:235], a[20:23]
    v_exp_f32 v119, v119
    v_mfma_f32_16x16x32_bf16 a[24:27], v[48:51], a[240:243], a[24:27]
    ds_read_b128 a[172:175], v19 offset:24576
    v_cvt_pk_bf16_f32 v66, v116, v117
    v_mfma_f32_16x16x32_bf16 a[24:27], v[52:55], a[244:247], a[24:27]
    v_exp_f32 v120, v120
    v_mfma_f32_16x16x32_bf16 a[28:31], v[52:55], a[252:255], a[28:31]
    v_exp_f32 v121, v121
    v_mfma_f32_16x16x32_bf16 a[28:31], v[48:51], a[248:251], a[28:31]
    ds_read_b128 a[168:171], v18 offset:24576
    v_cvt_pk_bf16_f32 v67, v118, v119
    v_smfmac_f32_16x16x64_bf16 v[220:223], v[216:219], v[48:55], v15
    v_exp_f32 v122, v122
    v_mfma_f32_16x16x32_bf16 a[60:63], v[56:59], a[248:251], a[60:63]
    v_exp_f32 v123, v123
    v_mfma_f32_16x16x32_bf16 a[60:63], v[60:63], a[252:255], a[60:63]
    ds_read_b128 a[164:167], v17 offset:24576
    v_cvt_pk_bf16_f32 v68, v120, v121
    v_mfma_f32_16x16x32_bf16 a[56:59], v[60:63], a[244:247], a[56:59]
    v_exp_f32 v124, v124
    v_mfma_f32_16x16x32_bf16 a[56:59], v[56:59], a[240:243], a[56:59]
    v_exp_f32 v125, v125
    v_mfma_f32_16x16x32_bf16 a[52:55], v[56:59], a[232:235], a[52:55]
    ds_read_b128 a[160:163], v16 offset:24576
    v_cvt_pk_bf16_f32 v69, v122, v123
    v_mfma_f32_16x16x32_bf16 a[52:55], v[60:63], a[236:239], a[52:55]
    v_exp_f32 v126, v126
    v_mfma_f32_16x16x32_bf16 a[48:51], v[60:63], a[228:231], a[48:51]
    v_exp_f32 v127, v127
    v_mfma_f32_16x16x32_bf16 a[48:51], v[56:59], a[224:227], a[48:51]
    ds_read_b128 a[144:147], v16 offset:20480
    v_cvt_pk_bf16_f32 v70, v124, v125
    v_mfma_f32_16x16x32_bf16 a[44:47], v[56:59], a[216:219], a[44:47]
    v_exp_f32 v140, v140
    v_mfma_f32_16x16x32_bf16 a[44:47], v[60:63], a[220:223], a[44:47]
    v_exp_f32 v141, v141
    v_mfma_f32_16x16x32_bf16 a[40:43], v[60:63], a[212:215], a[40:43]
    ds_read_b128 a[148:151], v17 offset:20480
    v_cvt_pk_bf16_f32 v71, v126, v127
    v_mfma_f32_16x16x32_bf16 a[40:43], v[56:59], a[208:211], a[40:43]
    v_exp_f32 v142, v142
    v_mfma_f32_16x16x32_bf16 a[36:39], v[56:59], a[200:203], a[36:39]
    v_exp_f32 v143, v143
    v_mfma_f32_16x16x32_bf16 a[36:39], v[60:63], a[204:207], a[36:39]
    ds_read_b128 a[152:155], v18 offset:20480
    v_cvt_pk_bf16_f32 v78, v140, v141
    v_mfma_f32_16x16x32_bf16 a[32:35], v[60:63], a[196:199], a[32:35]
    v_exp_f32 v136, v136
    v_mfma_f32_16x16x32_bf16 a[32:35], v[56:59], a[192:195], a[32:35]
    v_exp_f32 v137, v137
    v_smfmac_f32_16x16x64_bf16 v[224:227], v[216:219], v[56:63], v15
    ds_read_b128 a[156:159], v19 offset:20480
    v_cvt_pk_bf16_f32 v79, v142, v143
    v_mfma_f32_16x16x32_bf16 a[64:67], v[64:67], a[192:195], a[64:67]
    v_exp_f32 v138, v138
    v_mfma_f32_16x16x32_bf16 a[64:67], v[68:71], a[196:199], a[64:67]
    v_exp_f32 v139, v139
    v_mfma_f32_16x16x32_bf16 a[68:71], v[68:71], a[204:207], a[68:71]
    ds_read_b128 a[140:143], v19 offset:16384
    v_cvt_pk_bf16_f32 v76, v136, v137
    v_mfma_f32_16x16x32_bf16 a[68:71], v[64:67], a[200:203], a[68:71]
    v_exp_f32 v132, v132
    v_mfma_f32_16x16x32_bf16 a[72:75], v[64:67], a[208:211], a[72:75]
    v_exp_f32 v133, v133
    v_mfma_f32_16x16x32_bf16 a[72:75], v[68:71], a[212:215], a[72:75]
    ds_read_b128 a[136:139], v18 offset:16384
    v_cvt_pk_bf16_f32 v77, v138, v139
    v_mfma_f32_16x16x32_bf16 a[76:79], v[68:71], a[220:223], a[76:79]
    v_exp_f32 v134, v134
    v_mfma_f32_16x16x32_bf16 a[76:79], v[64:67], a[216:219], a[76:79]
    v_exp_f32 v135, v135
    v_mfma_f32_16x16x32_bf16 a[80:83], v[64:67], a[224:227], a[80:83]
    ds_read_b128 a[132:135], v17 offset:16384
    v_cvt_pk_bf16_f32 v74, v132, v133
    v_mfma_f32_16x16x32_bf16 a[80:83], v[68:71], a[228:231], a[80:83]
    v_exp_f32 v128, v128
    v_mfma_f32_16x16x32_bf16 a[84:87], v[68:71], a[236:239], a[84:87]
    v_exp_f32 v129, v129
    v_mfma_f32_16x16x32_bf16 a[84:87], v[64:67], a[232:235], a[84:87]
    ds_read_b128 a[128:131], v16 offset:16384
    v_cvt_pk_bf16_f32 v75, v134, v135
    v_mfma_f32_16x16x32_bf16 a[88:91], v[64:67], a[240:243], a[88:91]
    v_exp_f32 v130, v130
    v_mfma_f32_16x16x32_bf16 a[88:91], v[68:71], a[244:247], a[88:91]
    v_exp_f32 v131, v131
    v_mfma_f32_16x16x32_bf16 a[92:95], v[68:71], a[252:255], a[92:95]
    v_cvt_pk_bf16_f32 v72, v128, v129
    v_cvt_pk_bf16_f32 v73, v130, v131
    v_mfma_f32_16x16x32_bf16 a[92:95], v[64:67], a[248:251], a[92:95]
    s_add_u32 s4, s12, s30
    s_addc_u32 s5, s13, 0
    v_smfmac_f32_16x16x64_bf16 v[228:231], v[216:219], v[64:71], v15
    s_waitcnt vmcnt(8) lgkmcnt(0)
    s_barrier
    v_mfma_f32_16x16x32_bf16 a[124:127], v[72:75], a[248:251], a[124:127]
    s_add_u32 s31, s31, 1
    s_cmp_lt_u32 s31, 10
    v_mfma_f32_16x16x32_bf16 a[124:127], v[76:79], a[252:255], a[124:127]
    v_mfma_f32_16x16x32_bf16 a[120:123], v[76:79], a[244:247], a[120:123]
    v_mfma_f32_16x16x32_bf16 a[120:123], v[72:75], a[240:243], a[120:123]
    global_load_lds_dwordx4 v12, s[6:7]
    v_mfma_f32_16x16x32_bf16 a[116:119], v[72:75], a[232:235], a[116:119]
    ds_read_b64_tr_b16 a[248:249], v27 offset:16384
    v_mfma_f32_16x16x32_bf16 a[116:119], v[76:79], a[236:239], a[116:119]
    ds_read_b64_tr_b16 a[250:251], v27 offset:20480
    v_mfma_f32_16x16x32_bf16 a[112:115], v[76:79], a[228:231], a[112:115]
    ds_read_b64_tr_b16 a[252:253], v27 offset:24576
    v_mfma_f32_16x16x32_bf16 a[112:115], v[72:75], a[224:227], a[112:115]
    global_load_lds_dwordx4 v13, s[6:7] offset:1024
    v_mfma_f32_16x16x32_bf16 a[108:111], v[72:75], a[216:219], a[108:111]
    ds_read_b64_tr_b16 a[254:255], v27 offset:28672
    v_mfma_f32_16x16x32_bf16 a[108:111], v[76:79], a[220:223], a[108:111]
    ds_read_b64_tr_b16 a[240:241], v26 offset:16384
    v_mfma_f32_16x16x32_bf16 a[104:107], v[76:79], a[212:215], a[104:107]
    ds_read_b64_tr_b16 a[242:243], v26 offset:20480
    v_mfma_f32_16x16x32_bf16 a[104:107], v[72:75], a[208:211], a[104:107]
    global_load_lds_dwordx4 v12, s[6:7] offset:2048
    v_mfma_f32_16x16x32_bf16 a[100:103], v[72:75], a[200:203], a[100:103]
    ds_read_b64_tr_b16 a[244:245], v26 offset:24576
    v_mfma_f32_16x16x32_bf16 a[100:103], v[76:79], a[204:207], a[100:103]
    ds_read_b64_tr_b16 a[246:247], v26 offset:28672
    v_mfma_f32_16x16x32_bf16 a[96:99], v[76:79], a[196:199], a[96:99]
    ds_read_b64_tr_b16 a[232:233], v25 offset:16384
    v_mfma_f32_16x16x32_bf16 a[96:99], v[72:75], a[192:195], a[96:99]
    global_load_lds_dwordx4 v13, s[6:7] offset:3072
    v_smfmac_f32_16x16x64_bf16 v[232:235], v[216:219], v[72:79], v15
    s_mov_b32 m0, s97
    s_cbranch_scc1 L_loop
L_loopend:
    v_mfma_f32_16x16x32_bf16 v[80:83], a[128:131], v[144:147], v[32:35]
    ds_read_b64_tr_b16 a[234:235], v25 offset:20480
    ds_read_b64_tr_b16 a[236:237], v25 offset:24576
    v_mfma_f32_16x16x32_bf16 v[80:83], a[132:135], v[148:151], v[80:83]
    ds_read_b64_tr_b16 a[238:239], v25 offset:28672
    ds_read_b64_tr_b16 a[224:225], v24 offset:16384
    v_mfma_f32_16x16x32_bf16 v[80:83], a[136:139], v[152:155], v[80:83]
    ds_read_b64_tr_b16 a[226:227], v24 offset:20480
    ds_read_b64_tr_b16 a[228:229], v24 offset:24576
    v_mfma_f32_16x16x32_bf16 v[80:83], a[140:143], v[156:159], v[80:83]
    ds_read_b64_tr_b16 a[230:231], v24 offset:28672
    ds_read_b64_tr_b16 a[216:217], v23 offset:16384
    v_mfma_f32_16x16x32_bf16 v[84:87], a[156:159], v[156:159], v[32:35]
    ds_read_b64_tr_b16 a[218:219], v23 offset:20480
    ds_read_b64_tr_b16 a[220:221], v23 offset:24576
    v_mfma_f32_16x16x32_bf16 v[84:87], a[152:155], v[152:155], v[84:87]
    ds_read_b64_tr_b16 a[222:223], v23 offset:28672
    ds_read_b64_tr_b16 a[208:209], v22 offset:16384
    v_mfma_f32_16x16x32_bf16 v[84:87], a[148:151], v[148:151], v[84:87]
    ds_read_b64_tr_b16 a[210:211], v22 offset:20480
    ds_read_b64_tr_b16 a[212:213], v22 offset:24576
    v_mfma_f32_16x16x32_bf16 v[84:87], a[144:147], v[144:147], v[84:87]
    ds_read_b64_tr_b16 a[214:215], v22 offset:28672
    ds_read_b64_tr_b16 a[200:201], v21 offset:16384
    v_mfma_f32_16x16x32_bf16 v[88:91], a[160:163], v[144:147], v[32:35]
    ds_read_b64_tr_b16 a[202:203], v21 offset:20480
    ds_read_b64_tr_b16 a[204:205], v21 offset:24576
    v_mfma_f32_16x16x32_bf16 v[88:91], a[164:167], v[148:151], v[88:91]
    ds_read_b64_tr_b16 a[206:207], v21 offset:28672
    ds_read_b64_tr_b16 a[192:193], v20 offset:16384
    v_mfma_f32_16x16x32_bf16 v[88:91], a[168:171], v[152:155], v[88:91]
    ds_read_b64_tr_b16 a[194:195], v20 offset:20480
    ds_read_b64_tr_b16 a[196:197], v20 offset:24576
    v_mfma_f32_16x16x32_bf16 v[88:91], a[172:175], v[156:159], v[88:91]
    ds_read_b64_tr_b16 a[198:199], v20 offset:28672
    v_mfma_f32_16x16x32_bf16 v[92:95], a[188:191], v[156:159], v[32:35]
    v_mfma_f32_16x16x32_bf16 v[92:95], a[184:187], v[152:155], v[92:95]
    v_mfma_f32_16x16x32_bf16 v[92:95], a[180:183], v[148:151], v[92:95]
    v_mfma_f32_16x16x32_bf16 v[92:95], a[176:179], v[144:147], v[92:95]
    v_mfma_f32_16x16x32_bf16 v[108:111], a[176:179], v[160:163], v[36:39]
    v_exp_f32 v80, v80
    v_mfma_f32_16x16x32_bf16 v[108:111], a[180:183], v[164:167], v[108:111]
    v_exp_f32 v81, v81
    v_mfma_f32_16x16x32_bf16 v[108:111], a[184:187], v[168:171], v[108:111]
    v_exp_f32 v82, v82
    v_mfma_f32_16x16x32_bf16 v[108:111], a[188:191], v[172:175], v[108:111]
    v_exp_f32 v83, v83
    v_cvt_pk_bf16_f32 v48, v80, v81
    v_mfma_f32_16x16x32_bf16 v[104:107], a[172:175], v[172:175], v[36:39]
    v_exp_f32 v84, v84
    v_mfma_f32_16x16x32_bf16 v[104:107], a[168:171], v[168:171], v[104:107]
    v_exp_f32 v85, v85
    v_cvt_pk_bf16_f32 v49, v82, v83
    v_mfma_f32_16x16x32_bf16 v[104:107], a[164:167], v[164:167], v[104:107]
    v_exp_f32 v86, v86
    v_mfma_f32_16x16x32_bf16 v[104:107], a[160:163], v[160:163], v[104:107]
    v_exp_f32 v87, v87
    v_cvt_pk_bf16_f32 v50, v84, v85
    v_mfma_f32_16x16x32_bf16 v[100:103], a[144:147], v[160:163], v[36:39]
    v_exp_f32 v88, v88
    v_mfma_f32_16x16x32_bf16 v[100:103], a[148:151], v[164:167], v[100:103]
    v_exp_f32 v89, v89
    v_cvt_pk_bf16_f32 v51, v86, v87
    v_mfma_f32_16x16x32_bf16 v[100:103], a[152:155], v[168:171], v[100:103]
    v_exp_f32 v90, v90
    v_mfma_f32_16x16x32_bf16 v[100:103], a[156:159], v[172:175], v[100:103]
    v_exp_f32 v91, v91
    v_cvt_pk_bf16_f32 v52, v88, v89
    v_mfma_f32_16x16x32_bf16 v[96:99], a[140:143], v[172:175], v[36:39]
    v_exp_f32 v92, v92
    v_mfma_f32_16x16x32_bf16 v[96:99], a[136:139], v[168:171], v[96:99]
    v_exp_f32 v93, v93
    v_cvt_pk_bf16_f32 v53, v90, v91
    v_mfma_f32_16x16x32_bf16 v[96:99], a[132:135], v[164:167], v[96:99]
    v_exp_f32 v94, v94
    v_mfma_f32_16x16x32_bf16 v[96:99], a[128:131], v[160:163], v[96:99]
    v_exp_f32 v95, v95
    v_cvt_pk_bf16_f32 v54, v92, v93
    v_cvt_pk_bf16_f32 v55, v94, v95
    s_waitcnt lgkmcnt(0)
    v_mfma_f32_16x16x32_bf16 a[0:3], v[48:51], a[192:195], a[0:3]
    v_exp_f32 v108, v108
    v_mfma_f32_16x16x32_bf16 a[0:3], v[52:55], a[196:199], a[0:3]
    v_exp_f32 v109, v109
    v_mfma_f32_16x16x32_bf16 a[4:7], v[52:55], a[204:207], a[4:7]
    v_exp_f32 v110, v110
    v_mfma_f32_16x16x32_bf16 a[4:7], v[48:51], a[200:203], a[4:7]
    v_exp_f32 v111, v111
    v_cvt_pk_bf16_f32 v62, v108, v109
    v_mfma_f32_16x16x32_bf16 a[8:11], v[48:51], a[208:211], a[8:11]
    v_exp_f32 v104, v104
    v_mfma_f32_16x16x32_bf16 a[8:11], v[52:55], a[212:215], a[8:11]
    v_exp_f32 v105, v105
    v_cvt_pk_bf16_f32 v63, v110, v111
    v_mfma_f32_16x16x32_bf16 a[12:15], v[52:55], a[220:223], a[12:15]
    v_exp_f32 v106, v106
    v_mfma_f32_16x16x32_bf16 a[12:15], v[48:51], a[216:219], a[12:15]
    v_exp_f32 v107, v107
    v_cvt_pk_bf16_f32 v60, v104, v105
    v_mfma_f32_16x16x32_bf16 a[16:19], v[48:51], a[224:227], a[16:19]
    v_exp_f32 v100, v100
    v_mfma_f32_16x16x32_bf16 a[16:19], v[52:55], a[228:231], a[16:19]
    v_exp_f32 v101, v101
    v_cvt_pk_bf16_f32 v61, v106, v107
    v_mfma_f32_16x16x32_bf16 a[20:23], v[52:55], a[236:239], a[20:23]
    v_exp_f32 v102, v102
    v_mfma_f32_16x16x32_bf16 a[20:23], v[48:51], a[232:235], a[20:23]
    v_exp_f32 v103, v103
    v_cvt_pk_bf16_f32 v58, v100, v101
    v_mfma_f32_16x16x32_bf16 a[24:27], v[48:51], a[240:243], a[24:27]
    v_exp_f32 v96, v96
    v_mfma_f32_16x16x32_bf16 a[24:27], v[52:55], a[244:247], a[24:27]
    v_exp_f32 v97, v97
    v_cvt_pk_bf16_f32 v59, v102, v103
    v_mfma_f32_16x16x32_bf16 a[28:31], v[52:55], a[252:255], a[28:31]
    v_exp_f32 v98, v98
    v_mfma_f32_16x16x32_bf16 a[28:31], v[48:51], a[248:251], a[28:31]
    v_exp_f32 v99, v99
    v_smfmac_f32_16x16x64_bf16 v[220:223], v[216:219], v[48:55], v15
    v_cvt_pk_bf16_f32 v56, v96, v97
    v_cvt_pk_bf16_f32 v57, v98, v99
    s_nop 5
    v_add_f32 v214, v220, v221
    v_rcp_f32 v215, v214
    v_cmp_nle_f32 s[46:47], v214, s40
    v_accvgpr_read_b32 v244, a0
    v_accvgpr_read_b32 v245, a1
    v_mov_b32_dpp v215, v215 row_shl:4 row_mask:0x2 bank_mask:0xf
    v_accvgpr_read_b32 v246, a2
    v_accvgpr_read_b32 v247, a3
    v_mov_b32_dpp v215, v215 row_shl:8 row_mask:0x4 bank_mask:0xf
    v_accvgpr_read_b32 v248, a4
    v_accvgpr_read_b32 v249, a5
    v_mov_b32_dpp v215, v215 row_shl:12 row_mask:0x8 bank_mask:0xf
    v_accvgpr_read_b32 v250, a6
    v_accvgpr_read_b32 v251, a7
    v_mov_b32_dpp v6, v215 row_newbcast:0 row_mask:0xf bank_mask:0xf
    v_mov_b32_dpp v7, v215 row_newbcast:1 row_mask:0xf bank_mask:0xf
    v_mov_b32_dpp v8, v215 row_newbcast:2 row_mask:0xf bank_mask:0xf
    v_mov_b32_dpp v9, v215 row_newbcast:3 row_mask:0xf bank_mask:0xf
    s_or_b64 s[44:45], s[44:45], s[46:47]
    v_pk_mul_f32 v[244:245], v[244:245], v[6:7]
    v_pk_mul_f32 v[246:247], v[246:247], v[8:9]
    v_pk_mul_f32 v[248:249], v[248:249], v[6:7]
    v_pk_mul_f32 v[250:251], v[250:251], v[8:9]
    v_cvt_pk_bf16_f32 v236, v244, v245
    v_cvt_pk_bf16_f32 v237, v246, v247
    v_cvt_pk_bf16_f32 v238, v248, v249
    v_cvt_pk_bf16_f32 v239, v250, v251
    ds_write_b64 v208, v[236:237] offset:0
    ds_write_b64 v209, v[238:239] offset:512
    v_accvgpr_read_b32 v48, a8
    v_accvgpr_read_b32 v49, a9
    v_accvgpr_read_b32 v50, a10
    v_accvgpr_read_b32 v51, a11
    v_accvgpr_read_b32 v52, a12
    v_accvgpr_read_b32 v53, a13
    v_accvgpr_read_b32 v54, a14
    v_accvgpr_read_b32 v55, a15
    v_pk_mul_f32 v[48:49], v[48:49], v[6:7]
    v_pk_mul_f32 v[50:51], v[50:51], v[8:9]
    v_pk_mul_f32 v[52:53], v[52:53], v[6:7]
    v_pk_mul_f32 v[54:55], v[54:55], v[8:9]
    v_cvt_pk_bf16_f32 v240, v48, v49
    v_cvt_pk_bf16_f32 v241, v50, v51
    v_cvt_pk_bf16_f32 v242, v52, v53
    v_cvt_pk_bf16_f32 v243, v54, v55
    ds_write_b64 v210, v[240:241] offset:1024
    ds_write_b64 v211, v[242:243] offset:1536
    v_accvgpr_read_b32 v244, a16
    v_accvgpr_read_b32 v245, a17
    v_accvgpr_read_b32 v246, a18
    v_accvgpr_read_b32 v247, a19
    v_accvgpr_read_b32 v248, a20
    v_accvgpr_read_b32 v249, a21
    v_accvgpr_read_b32 v250, a22
    v_accvgpr_read_b32 v251, a23
    v_pk_mul_f32 v[244:245], v[244:245], v[6:7]
    v_pk_mul_f32 v[246:247], v[246:247], v[8:9]
    v_pk_mul_f32 v[248:249], v[248:249], v[6:7]
    v_pk_mul_f32 v[250:251], v[250:251], v[8:9]
    v_cvt_pk_bf16_f32 v236, v244, v245
    v_cvt_pk_bf16_f32 v237, v246, v247
    v_cvt_pk_bf16_f32 v238, v248, v249
    v_cvt_pk_bf16_f32 v239, v250, v251
    ds_write_b64 v208, v[236:237] offset:2048
    ds_write_b64 v209, v[238:239] offset:2560
    v_accvgpr_read_b32 v48, a24
    v_accvgpr_read_b32 v49, a25
    v_accvgpr_read_b32 v50, a26
    v_accvgpr_read_b32 v51, a27
    v_accvgpr_read_b32 v52, a28
    v_accvgpr_read_b32 v53, a29
    v_accvgpr_read_b32 v54, a30
    v_accvgpr_read_b32 v55, a31
    v_pk_mul_f32 v[48:49], v[48:49], v[6:7]
    v_pk_mul_f32 v[50:51], v[50:51], v[8:9]
    v_pk_mul_f32 v[52:53], v[52:53], v[6:7]
    v_pk_mul_f32 v[54:55], v[54:55], v[8:9]
    v_cvt_pk_bf16_f32 v240, v48, v49
    v_cvt_pk_bf16_f32 v241, v50, v51
    v_cvt_pk_bf16_f32 v242, v52, v53
    v_cvt_pk_bf16_f32 v243, v54, v55
    ds_write_b64 v210, v[240:241] offset:3072
    ds_write_b64 v211, v[242:243] offset:3584
    ds_read_b64_tr_b16 v[80:81], v212 offset:0
    ds_read_b64_tr_b16 v[82:83], v213 offset:128
    ds_read_b64_tr_b16 v[84:85], v252 offset:256
    ds_read_b64_tr_b16 v[86:87], v253 offset:384
    ds_read_b64_tr_b16 v[88:89], v252 offset:0
    ds_read_b64_tr_b16 v[90:91], v253 offset:128
    ds_read_b64_tr_b16 v[92:93], v212 offset:256
    ds_read_b64_tr_b16 v[94:95], v213 offset:384
    v_mfma_f32_16x16x32_bf16 v[112:115], a[128:131], v[176:179], v[40:43]
    v_mfma_f32_16x16x32_bf16 v[112:115], a[132:135], v[180:183], v[112:115]
    v_mfma_f32_16x16x32_bf16 v[112:115], a[136:139], v[184:187], v[112:115]
    v_mfma_f32_16x16x32_bf16 v[112:115], a[140:143], v[188:191], v[112:115]
    v_mfma_f32_16x16x32_bf16 v[116:119], a[156:159], v[188:191], v[40:43]
    s_waitcnt lgkmcnt(0)
    s_mov_b64 vcc, s[94:95]
    v_cndmask_b32_dpp v48, v84, v80, vcc quad_perm:[1,0,3,2] row_mask:0xf bank_mask:0xf
    v_mfma_f32_16x16x32_bf16 v[116:119], a[152:155], v[184:187], v[116:119]
    v_cndmask_b32_dpp v49, v85, v81, vcc quad_perm:[1,0,3,2] row_mask:0xf bank_mask:0xf
    v_cndmask_b32_dpp v50, v86, v82, vcc quad_perm:[1,0,3,2] row_mask:0xf bank_mask:0xf
    v_cndmask_b32_dpp v51, v87, v83, vcc quad_perm:[1,0,3,2] row_mask:0xf bank_mask:0xf
    v_mfma_f32_16x16x32_bf16 v[116:119], a[148:151], v[180:183], v[116:119]
    v_cndmask_b32_dpp v52, v92, v88, vcc quad_perm:[1,0,3,2] row_mask:0xf bank_mask:0xf
    v_cndmask_b32_dpp v53, v93, v89, vcc quad_perm:[1,0,3,2] row_mask:0xf bank_mask:0xf
    v_cndmask_b32_dpp v54, v94, v90, vcc quad_perm:[1,0,3,2] row_mask:0xf bank_mask:0xf
    v_mfma_f32_16x16x32_bf16 v[116:119], a[144:147], v[176:179], v[116:119]
    v_cndmask_b32_dpp v55, v95, v91, vcc quad_perm:[1,0,3,2] row_mask:0xf bank_mask:0xf
    s_not_b64 vcc, vcc
    v_cndmask_b32_dpp v84, v80, v84, vcc quad_perm:[1,0,3,2] row_mask:0xf bank_mask:0xf
    v_mfma_f32_16x16x32_bf16 v[120:123], a[160:163], v[176:179], v[40:43]
    v_cndmask_b32_dpp v85, v81, v85, vcc quad_perm:[1,0,3,2] row_mask:0xf bank_mask:0xf
    v_cndmask_b32_dpp v86, v82, v86, vcc quad_perm:[1,0,3,2] row_mask:0xf bank_mask:0xf
    v_cndmask_b32_dpp v87, v83, v87, vcc quad_perm:[1,0,3,2] row_mask:0xf bank_mask:0xf
    v_mfma_f32_16x16x32_bf16 v[120:123], a[164:167], v[180:183], v[120:123]
    v_cndmask_b32_dpp v92, v88, v92, vcc quad_perm:[1,0,3,2] row_mask:0xf bank_mask:0xf
    v_cndmask_b32_dpp v93, v89, v93, vcc quad_perm:[1,0,3,2] row_mask:0xf bank_mask:0xf
    v_cndmask_b32_dpp v94, v90, v94, vcc quad_perm:[1,0,3,2] row_mask:0xf bank_mask:0xf
    v_mfma_f32_16x16x32_bf16 v[120:123], a[168:171], v[184:187], v[120:123]
    v_cndmask_b32_dpp v95, v91, v95, vcc quad_perm:[1,0,3,2] row_mask:0xf bank_mask:0xf
    buffer_store_dwordx4 v[48:51], v14, s[20:23], s36 offen offset:0 sc1
    buffer_store_dwordx4 v[52:55], v14, s[20:23], s36 offen offset:2048 sc1
    v_mfma_f32_16x16x32_bf16 v[120:123], a[172:175], v[188:191], v[120:123]
    buffer_store_dwordx4 v[84:87], v14, s[20:23], s36 offen offset:256 sc1
    buffer_store_dwordx4 v[92:95], v14, s[20:23], s36 offen offset:2304 sc1
    v_exp_f32 v112, v112
    v_mfma_f32_16x16x32_bf16 v[124:127], a[188:191], v[188:191], v[40:43]
    v_exp_f32 v113, v113
    v_exp_f32 v114, v114
    v_mfma_f32_16x16x32_bf16 v[124:127], a[184:187], v[184:187], v[124:127]
    v_exp_f32 v115, v115
    v_cvt_pk_bf16_f32 v64, v112, v113
    v_exp_f32 v116, v116
    v_mfma_f32_16x16x32_bf16 v[124:127], a[180:183], v[180:183], v[124:127]
    v_exp_f32 v117, v117
    v_cvt_pk_bf16_f32 v65, v114, v115
    v_mfma_f32_16x16x32_bf16 v[124:127], a[176:179], v[176:179], v[124:127]
    v_exp_f32 v118, v118
    v_exp_f32 v119, v119
    v_cvt_pk_bf16_f32 v66, v116, v117
    v_mfma_f32_16x16x32_bf16 a[60:63], v[56:59], a[248:251], a[60:63]
    v_exp_f32 v120, v120
    v_mfma_f32_16x16x32_bf16 a[60:63], v[60:63], a[252:255], a[60:63]
    v_exp_f32 v121, v121
    v_mfma_f32_16x16x32_bf16 a[56:59], v[60:63], a[244:247], a[56:59]
    v_cvt_pk_bf16_f32 v67, v118, v119
    v_mfma_f32_16x16x32_bf16 a[56:59], v[56:59], a[240:243], a[56:59]
    v_exp_f32 v122, v122
    v_mfma_f32_16x16x32_bf16 a[52:55], v[56:59], a[232:235], a[52:55]
    v_exp_f32 v123, v123
    v_mfma_f32_16x16x32_bf16 a[52:55], v[60:63], a[236:239], a[52:55]
    v_cvt_pk_bf16_f32 v68, v120, v121
    v_mfma_f32_16x16x32_bf16 a[48:51], v[60:63], a[228:231], a[48:51]
    v_exp_f32 v124, v124
    v_mfma_f32_16x16x32_bf16 a[48:51], v[56:59], a[224:227], a[48:51]
    v_exp_f32 v125, v125
    v_mfma_f32_16x16x32_bf16 a[44:47], v[56:59], a[216:219], a[44:47]
    v_cvt_pk_bf16_f32 v69, v122, v123
    v_mfma_f32_16x16x32_bf16 a[44:47], v[60:63], a[220:223], a[44:47]
    v_exp_f32 v126, v126
    v_mfma_f32_16x16x32_bf16 a[40:43], v[60:63], a[212:215], a[40:43]
    v_exp_f32 v127, v127
    v_mfma_f32_16x16x32_bf16 a[40:43], v[56:59], a[208:211], a[40:43]
    v_cvt_pk_bf16_f32 v70, v124, v125
    v_cvt_pk_bf16_f32 v71, v126, v127
    v_mfma_f32_16x16x32_bf16 a[36:39], v[56:59], a[200:203], a[36:39]
    v_mfma_f32_16x16x32_bf16 a[36:39], v[60:63], a[204:207], a[36:39]
    v_mfma_f32_16x16x32_bf16 a[32:35], v[60:63], a[196:199], a[32:35]
    v_mfma_f32_16x16x32_bf16 a[32:35], v[56:59], a[192:195], a[32:35]
    v_smfmac_f32_16x16x64_bf16 v[224:227], v[216:219], v[56:63], v15
    s_nop 7
    v_add_f32 v214, v224, v225
    v_rcp_f32 v215, v214
    v_cmp_nle_f32 s[46:47], v214, s40
    v_accvgpr_read_b32 v244, a32
    v_accvgpr_read_b32 v245, a33
    v_mov_b32_dpp v215, v215 row_shl:4 row_mask:0x2 bank_mask:0xf
    v_accvgpr_read_b32 v246, a34
    v_accvgpr_read_b32 v247, a35
    v_mov_b32_dpp v215, v215 row_shl:8 row_mask:0x4 bank_mask:0xf
    v_accvgpr_read_b32 v248, a36
    v_accvgpr_read_b32 v249, a37
    v_mov_b32_dpp v215, v215 row_shl:12 row_mask:0x8 bank_mask:0xf
    v_accvgpr_read_b32 v250, a38
    v_accvgpr_read_b32 v251, a39
    v_mov_b32_dpp v6, v215 row_newbcast:0 row_mask:0xf bank_mask:0xf
    v_mov_b32_dpp v7, v215 row_newbcast:1 row_mask:0xf bank_mask:0xf
    v_mov_b32_dpp v8, v215 row_newbcast:2 row_mask:0xf bank_mask:0xf
    v_mov_b32_dpp v9, v215 row_newbcast:3 row_mask:0xf bank_mask:0xf
    s_or_b64 s[44:45], s[44:45], s[46:47]
    v_pk_mul_f32 v[244:245], v[244:245], v[6:7]
    v_pk_mul_f32 v[246:247], v[246:247], v[8:9]
    v_pk_mul_f32 v[248:249], v[248:249], v[6:7]
    v_pk_mul_f32 v[250:251], v[250:251], v[8:9]
    v_cvt_pk_bf16_f32 v236, v244, v245
    v_cvt_pk_bf16_f32 v237, v246, v247
    v_cvt_pk_bf16_f32 v238, v248, v249
    v_cvt_pk_bf16_f32 v239, v250, v251
    ds_write_b64 v208, v[236:237] offset:4096
    ds_write_b64 v209, v[238:239] offset:4608
    v_accvgpr_read_b32 v56, a40
    v_accvgpr_read_b32 v57, a41
    v_accvgpr_read_b32 v58, a42
    v_accvgpr_read_b32 v59, a43
    v_accvgpr_read_b32 v60, a44
    v_accvgpr_read_b32 v61, a45
    v_accvgpr_read_b32 v62, a46
    v_accvgpr_read_b32 v63, a47
    v_pk_mul_f32 v[56:57], v[56:57], v[6:7]
    v_pk_mul_f32 v[58:59], v[58:59], v[8:9]
    v_pk_mul_f32 v[60:61], v[60:61], v[6:7]
    v_pk_mul_f32 v[62:63], v[62:63], v[8:9]
    v_cvt_pk_bf16_f32 v240, v56, v57
    v_cvt_pk_bf16_f32 v241, v58, v59
    v_cvt_pk_bf16_f32 v242, v60, v61
    v_cvt_pk_bf16_f32 v243, v62, v63
    ds_write_b64 v210, v[240:241] offset:5120
    ds_write_b64 v211, v[242:243] offset:5632
    v_accvgpr_read_b32 v244, a48
    v_accvgpr_read_b32 v245, a49
    v_accvgpr_read_b32 v246, a50
    v_accvgpr_read_b32 v247, a51
    v_accvgpr_read_b32 v248, a52
    v_accvgpr_read_b32 v249, a53
    v_accvgpr_read_b32 v250, a54
    v_accvgpr_read_b32 v251, a55
    v_pk_mul_f32 v[244:245], v[244:245], v[6:7]
    v_pk_mul_f32 v[246:247], v[246:247], v[8:9]
    v_pk_mul_f32 v[248:249], v[248:249], v[6:7]
    v_pk_mul_f32 v[250:251], v[250:251], v[8:9]
    v_cvt_pk_bf16_f32 v236, v244, v245
    v_cvt_pk_bf16_f32 v237, v246, v247
    v_cvt_pk_bf16_f32 v238, v248, v249
    v_cvt_pk_bf16_f32 v239, v250, v251
    ds_write_b64 v208, v[236:237] offset:6144
    ds_write_b64 v209, v[238:239] offset:6656
    v_accvgpr_read_b32 v56, a56
    v_accvgpr_read_b32 v57, a57
    v_accvgpr_read_b32 v58, a58
    v_accvgpr_read_b32 v59, a59
    v_accvgpr_read_b32 v60, a60
    v_accvgpr_read_b32 v61, a61
    v_accvgpr_read_b32 v62, a62
    v_accvgpr_read_b32 v63, a63
    v_pk_mul_f32 v[56:57], v[56:57], v[6:7]
    v_pk_mul_f32 v[58:59], v[58:59], v[8:9]
    v_pk_mul_f32 v[60:61], v[60:61], v[6:7]
    v_pk_mul_f32 v[62:63], v[62:63], v[8:9]
    v_cvt_pk_bf16_f32 v240, v56, v57
    v_cvt_pk_bf16_f32 v241, v58, v59
    v_cvt_pk_bf16_f32 v242, v60, v61
    v_cvt_pk_bf16_f32 v243, v62, v63
    ds_write_b64 v210, v[240:241] offset:7168
    ds_write_b64 v211, v[242:243] offset:7680
    ds_read_b64_tr_b16 v[96:97], v212 offset:4096
    ds_read_b64_tr_b16 v[98:99], v213 offset:4224
    ds_read_b64_tr_b16 v[100:101], v252 offset:4352
    ds_read_b64_tr_b16 v[102:103], v253 offset:4480
    ds_read_b64_tr_b16 v[104:105], v252 offset:4096
    ds_read_b64_tr_b16 v[106:107], v253 offset:4224
    ds_read_b64_tr_b16 v[108:109], v212 offset:4352
    ds_read_b64_tr_b16 v[110:111], v213 offset:4480
    v_mfma_f32_16x16x32_bf16 v[140:143], a[176:179], v[192:195], v[44:47]
    v_mfma_f32_16x16x32_bf16 v[140:143], a[180:183], v[196:199], v[140:143]
    v_mfma_f32_16x16x32_bf16 v[140:143], a[184:187], v[200:203], v[140:143]
    v_mfma_f32_16x16x32_bf16 v[140:143], a[188:191], v[204:207], v[140:143]
    v_mfma_f32_16x16x32_bf16 v[136:139], a[172:175], v[204:207], v[44:47]
    s_waitcnt lgkmcnt(0)
    s_mov_b64 vcc, s[94:95]
    v_cndmask_b32_dpp v56, v100, v96, vcc quad_perm:[1,0,3,2] row_mask:0xf bank_mask:0xf
    v_mfma_f32_16x16x32_bf16 v[136:139], a[168:171], v[200:203], v[136:139]
    v_cndmask_b32_dpp v57, v101, v97, vcc quad_perm:[1,0,3,2] row_mask:0xf bank_mask:0xf
    v_cndmask_b32_dpp v58, v102, v98, vcc quad_perm:[1,0,3,2] row_mask:0xf bank_mask:0xf
    v_cndmask_b32_dpp v59, v103, v99, vcc quad_perm:[1,0,3,2] row_mask:0xf bank_mask:0xf
    v_mfma_f32_16x16x32_bf16 v[136:139], a[164:167], v[196:199], v[136:139]
    v_cndmask_b32_dpp v60, v108, v104, vcc quad_perm:[1,0,3,2] row_mask:0xf bank_mask:0xf
    v_cndmask_b32_dpp v61, v109, v105, vcc quad_perm:[1,0,3,2] row_mask:0xf bank_mask:0xf
    v_cndmask_b32_dpp v62, v110, v106, vcc quad_perm:[1,0,3,2] row_mask:0xf bank_mask:0xf
    v_mfma_f32_16x16x32_bf16 v[136:139], a[160:163], v[192:195], v[136:139]
    v_cndmask_b32_dpp v63, v111, v107, vcc quad_perm:[1,0,3,2] row_mask:0xf bank_mask:0xf
    s_not_b64 vcc, vcc
    v_cndmask_b32_dpp v100, v96, v100, vcc quad_perm:[1,0,3,2] row_mask:0xf bank_mask:0xf
    v_mfma_f32_16x16x32_bf16 v[132:135], a[144:147], v[192:195], v[44:47]
    v_cndmask_b32_dpp v101, v97, v101, vcc quad_perm:[1,0,3,2] row_mask:0xf bank_mask:0xf
    v_cndmask_b32_dpp v102, v98, v102, vcc quad_perm:[1,0,3,2] row_mask:0xf bank_mask:0xf
    v_cndmask_b32_dpp v103, v99, v103, vcc quad_perm:[1,0,3,2] row_mask:0xf bank_mask:0xf
    v_mfma_f32_16x16x32_bf16 v[132:135], a[148:151], v[196:199], v[132:135]
    v_cndmask_b32_dpp v108, v104, v108, vcc quad_perm:[1,0,3,2] row_mask:0xf bank_mask:0xf
    v_cndmask_b32_dpp v109, v105, v109, vcc quad_perm:[1,0,3,2] row_mask:0xf bank_mask:0xf
    v_cndmask_b32_dpp v110, v106, v110, vcc quad_perm:[1,0,3,2] row_mask:0xf bank_mask:0xf
    v_mfma_f32_16x16x32_bf16 v[132:135], a[152:155], v[200:203], v[132:135]
    v_cndmask_b32_dpp v111, v107, v111, vcc quad_perm:[1,0,3,2] row_mask:0xf bank_mask:0xf
    buffer_store_dwordx4 v[56:59], v14, s[20:23], s37 offen offset:0 sc1
    buffer_store_dwordx4 v[60:63], v14, s[20:23], s37 offen offset:2048 sc1
    v_mfma_f32_16x16x32_bf16 v[132:135], a[156:159], v[204:207], v[132:135]
    buffer_store_dwordx4 v[100:103], v14, s[20:23], s37 offen offset:256 sc1
    buffer_store_dwordx4 v[108:111], v14, s[20:23], s37 offen offset:2304 sc1
    v_exp_f32 v140, v140
    v_mfma_f32_16x16x32_bf16 v[128:131], a[140:143], v[204:207], v[44:47]
    v_exp_f32 v141, v141
    v_exp_f32 v142, v142
    v_mfma_f32_16x16x32_bf16 v[128:131], a[136:139], v[200:203], v[128:131]
    v_exp_f32 v143, v143
    v_cvt_pk_bf16_f32 v78, v140, v141
    v_exp_f32 v136, v136
    v_mfma_f32_16x16x32_bf16 v[128:131], a[132:135], v[196:199], v[128:131]
    v_exp_f32 v137, v137
    v_cvt_pk_bf16_f32 v79, v142, v143
    v_mfma_f32_16x16x32_bf16 v[128:131], a[128:131], v[192:195], v[128:131]
    v_exp_f32 v138, v138
    v_exp_f32 v139, v139
    v_cvt_pk_bf16_f32 v76, v136, v137
    v_mfma_f32_16x16x32_bf16 a[64:67], v[64:67], a[192:195], a[64:67]
    v_exp_f32 v132, v132
    v_mfma_f32_16x16x32_bf16 a[64:67], v[68:71], a[196:199], a[64:67]
    v_exp_f32 v133, v133
    v_mfma_f32_16x16x32_bf16 a[68:71], v[68:71], a[204:207], a[68:71]
    v_cvt_pk_bf16_f32 v77, v138, v139
    v_mfma_f32_16x16x32_bf16 a[68:71], v[64:67], a[200:203], a[68:71]
    v_exp_f32 v134, v134
    v_mfma_f32_16x16x32_bf16 a[72:75], v[64:67], a[208:211], a[72:75]
    v_exp_f32 v135, v135
    v_mfma_f32_16x16x32_bf16 a[72:75], v[68:71], a[212:215], a[72:75]
    v_cvt_pk_bf16_f32 v74, v132, v133
    v_mfma_f32_16x16x32_bf16 a[76:79], v[68:71], a[220:223], a[76:79]
    v_exp_f32 v128, v128
    v_mfma_f32_16x16x32_bf16 a[76:79], v[64:67], a[216:219], a[76:79]
    v_exp_f32 v129, v129
    v_mfma_f32_16x16x32_bf16 a[80:83], v[64:67], a[224:227], a[80:83]
    v_cvt_pk_bf16_f32 v75, v134, v135
    v_mfma_f32_16x16x32_bf16 a[80:83], v[68:71], a[228:231], a[80:83]
    v_exp_f32 v130, v130
    v_mfma_f32_16x16x32_bf16 a[84:87], v[68:71], a[236:239], a[84:87]
    v_exp_f32 v131, v131
    v_mfma_f32_16x16x32_bf16 a[84:87], v[64:67], a[232:235], a[84:87]
    v_cvt_pk_bf16_f32 v72, v128, v129
    v_cvt_pk_bf16_f32 v73, v130, v131
    v_mfma_f32_16x16x32_bf16 a[88:91], v[64:67], a[240:243], a[88:91]
    v_mfma_f32_16x16x32_bf16 a[88:91], v[68:71], a[244:247], a[88:91]
    v_mfma_f32_16x16x32_bf16 a[92:95], v[68:71], a[252:255], a[92:95]
    v_mfma_f32_16x16x32_bf16 a[92:95], v[64:67], a[248:251], a[92:95]
    v_smfmac_f32_16x16x64_bf16 v[228:231], v[216:219], v[64:71], v15
    s_nop 7
    v_add_f32 v214, v228, v229
    v_rcp_f32 v215, v214
    v_cmp_nle_f32 s[46:47], v214, s40
    v_accvgpr_read_b32 v244, a64
    v_accvgpr_read_b32 v245, a65
    v_mov_b32_dpp v215, v215 row_shl:4 row_mask:0x2 bank_mask:0xf
    v_accvgpr_read_b32 v246, a66
    v_accvgpr_read_b32 v247, a67
    v_mov_b32_dpp v215, v215 row_shl:8 row_mask:0x4 bank_mask:0xf
    v_accvgpr_read_b32 v248, a68
    v_accvgpr_read_b32 v249, a69
    v_mov_b32_dpp v215, v215 row_shl:12 row_mask:0x8 bank_mask:0xf
    v_accvgpr_read_b32 v250, a70
    v_accvgpr_read_b32 v251, a71
    v_mov_b32_dpp v6, v215 row_newbcast:0 row_mask:0xf bank_mask:0xf
    v_mov_b32_dpp v7, v215 row_newbcast:1 row_mask:0xf bank_mask:0xf
    v_mov_b32_dpp v8, v215 row_newbcast:2 row_mask:0xf bank_mask:0xf
    v_mov_b32_dpp v9, v215 row_newbcast:3 row_mask:0xf bank_mask:0xf
    s_or_b64 s[44:45], s[44:45], s[46:47]
    v_pk_mul_f32 v[244:245], v[244:245], v[6:7]
    v_pk_mul_f32 v[246:247], v[246:247], v[8:9]
    v_pk_mul_f32 v[248:249], v[248:249], v[6:7]
    v_pk_mul_f32 v[250:251], v[250:251], v[8:9]
    v_cvt_pk_bf16_f32 v236, v244, v245
    v_cvt_pk_bf16_f32 v237, v246, v247
    v_cvt_pk_bf16_f32 v238, v248, v249
    v_cvt_pk_bf16_f32 v239, v250, v251
    ds_write_b64 v208, v[236:237] offset:0
    ds_write_b64 v209, v[238:239] offset:512
    v_accvgpr_read_b32 v64, a72
    v_accvgpr_read_b32 v65, a73
    v_accvgpr_read_b32 v66, a74
    v_accvgpr_read_b32 v67, a75
    v_accvgpr_read_b32 v68, a76
    v_accvgpr_read_b32 v69, a77
    v_accvgpr_read_b32 v70, a78
    v_accvgpr_read_b32 v71, a79
    v_pk_mul_f32 v[64:65], v[64:65], v[6:7]
    v_pk_mul_f32 v[66:67], v[66:67], v[8:9]
    v_pk_mul_f32 v[68:69], v[68:69], v[6:7]
    v_pk_mul_f32 v[70:71], v[70:71], v[8:9]
    v_cvt_pk_bf16_f32 v240, v64, v65
    v_cvt_pk_bf16_f32 v241, v66, v67
    v_cvt_pk_bf16_f32 v242, v68, v69
    v_cvt_pk_bf16_f32 v243, v70, v71
    ds_write_b64 v210, v[240:241] offset:1024
    ds_write_b64 v211, v[242:243] offset:1536
    v_accvgpr_read_b32 v244, a80
    v_accvgpr_read_b32 v245, a81
    v_accvgpr_read_b32 v246, a82
    v_accvgpr_read_b32 v247, a83
    v_accvgpr_read_b32 v248, a84
    v_accvgpr_read_b32 v249, a85
    v_accvgpr_read_b32 v250, a86
    v_accvgpr_read_b32 v251, a87
    v_pk_mul_f32 v[244:245], v[244:245], v[6:7]
    v_pk_mul_f32 v[246:247], v[246:247], v[8:9]
    v_pk_mul_f32 v[248:249], v[248:249], v[6:7]
    v_pk_mul_f32 v[250:251], v[250:251], v[8:9]
    v_cvt_pk_bf16_f32 v236, v244, v245
    v_cvt_pk_bf16_f32 v237, v246, v247
    v_cvt_pk_bf16_f32 v238, v248, v249
    v_cvt_pk_bf16_f32 v239, v250, v251
    ds_write_b64 v208, v[236:237] offset:2048
    ds_write_b64 v209, v[238:239] offset:2560
    v_accvgpr_read_b32 v64, a88
    v_accvgpr_read_b32 v65, a89
    v_accvgpr_read_b32 v66, a90
    v_accvgpr_read_b32 v67, a91
    v_accvgpr_read_b32 v68, a92
    v_accvgpr_read_b32 v69, a93
    v_accvgpr_read_b32 v70, a94
    v_accvgpr_read_b32 v71, a95
    v_pk_mul_f32 v[64:65], v[64:65], v[6:7]
    v_pk_mul_f32 v[66:67], v[66:67], v[8:9]
    v_pk_mul_f32 v[68:69], v[68:69], v[6:7]
    v_pk_mul_f32 v[70:71], v[70:71], v[8:9]
    v_cvt_pk_bf16_f32 v240, v64, v65
    v_cvt_pk_bf16_f32 v241, v66, v67
    v_cvt_pk_bf16_f32 v242, v68, v69
    v_cvt_pk_bf16_f32 v243, v70, v71
    ds_write_b64 v210, v[240:241] offset:3072
    ds_write_b64 v211, v[242:243] offset:3584
    ds_read_b64_tr_b16 v[112:113], v212 offset:0
    ds_read_b64_tr_b16 v[114:115], v213 offset:128
    ds_read_b64_tr_b16 v[116:117], v252 offset:256
    ds_read_b64_tr_b16 v[118:119], v253 offset:384
    ds_read_b64_tr_b16 v[120:121], v252 offset:0
    ds_read_b64_tr_b16 v[122:123], v253 offset:128
    ds_read_b64_tr_b16 v[124:125], v212 offset:256
    ds_read_b64_tr_b16 v[126:127], v213 offset:384
    v_mfma_f32_16x16x32_bf16 a[124:127], v[72:75], a[248:251], a[124:127]
    v_mfma_f32_16x16x32_bf16 a[124:127], v[76:79], a[252:255], a[124:127]
    v_mfma_f32_16x16x32_bf16 a[120:123], v[76:79], a[244:247], a[120:123]
    v_mfma_f32_16x16x32_bf16 a[120:123], v[72:75], a[240:243], a[120:123]
    v_mfma_f32_16x16x32_bf16 a[116:119], v[72:75], a[232:235], a[116:119]
    s_waitcnt lgkmcnt(0)
    s_mov_b64 vcc, s[94:95]
    v_mfma_f32_16x16x32_bf16 a[116:119], v[76:79], a[236:239], a[116:119]
    v_cndmask_b32_dpp v64, v116, v112, vcc quad_perm:[1,0,3,2] row_mask:0xf bank_mask:0xf
    v_cndmask_b32_dpp v65, v117, v113, vcc quad_perm:[1,0,3,2] row_mask:0xf bank_mask:0xf
    v_mfma_f32_16x16x32_bf16 a[112:115], v[76:79], a[228:231], a[112:115]
    v_cndmask_b32_dpp v66, v118, v114, vcc quad_perm:[1,0,3,2] row_mask:0xf bank_mask:0xf
    v_cndmask_b32_dpp v67, v119, v115, vcc quad_perm:[1,0,3,2] row_mask:0xf bank_mask:0xf
    v_mfma_f32_16x16x32_bf16 a[112:115], v[72:75], a[224:227], a[112:115]
    v_cndmask_b32_dpp v68, v124, v120, vcc quad_perm:[1,0,3,2] row_mask:0xf bank_mask:0xf
    v_cndmask_b32_dpp v69, v125, v121, vcc quad_perm:[1,0,3,2] row_mask:0xf bank_mask:0xf
    v_mfma_f32_16x16x32_bf16 a[108:111], v[72:75], a[216:219], a[108:111]
    v_cndmask_b32_dpp v70, v126, v122, vcc quad_perm:[1,0,3,2] row_mask:0xf bank_mask:0xf
    v_cndmask_b32_dpp v71, v127, v123, vcc quad_perm:[1,0,3,2] row_mask:0xf bank_mask:0xf
    v_mfma_f32_16x16x32_bf16 a[108:111], v[76:79], a[220:223], a[108:111]
    s_not_b64 vcc, vcc
    v_cndmask_b32_dpp v116, v112, v116, vcc quad_perm:[1,0,3,2] row_mask:0xf bank_mask:0xf
    v_mfma_f32_16x16x32_bf16 a[104:107], v[76:79], a[212:215], a[104:107]
    v_cndmask_b32_dpp v117, v113, v117, vcc quad_perm:[1,0,3,2] row_mask:0xf bank_mask:0xf
    v_cndmask_b32_dpp v118, v114, v118, vcc quad_perm:[1,0,3,2] row_mask:0xf bank_mask:0xf
    v_mfma_f32_16x16x32_bf16 a[104:107], v[72:75], a[208:211], a[104:107]
    v_cndmask_b32_dpp v119, v115, v119, vcc quad_perm:[1,0,3,2] row_mask:0xf bank_mask:0xf
    v_cndmask_b32_dpp v124, v120, v124, vcc quad_perm:[1,0,3,2] row_mask:0xf bank_mask:0xf
    v_mfma_f32_16x16x32_bf16 a[100:103], v[72:75], a[200:203], a[100:103]
    v_cndmask_b32_dpp v125, v121, v125, vcc quad_perm:[1,0,3,2] row_mask:0xf bank_mask:0xf
    v_cndmask_b32_dpp v126, v122, v126, vcc quad_perm:[1,0,3,2] row_mask:0xf bank_mask:0xf
    v_mfma_f32_16x16x32_bf16 a[100:103], v[76:79], a[204:207], a[100:103]
    v_cndmask_b32_dpp v127, v123, v127, vcc quad_perm:[1,0,3,2] row_mask:0xf bank_mask:0xf
    buffer_store_dwordx4 v[64:67], v14, s[20:23], s38 offen offset:0 sc1
    v_mfma_f32_16x16x32_bf16 a[96:99], v[76:79], a[196:199], a[96:99]
    buffer_store_dwordx4 v[68:71], v14, s[20:23], s38 offen offset:2048 sc1
    buffer_store_dwordx4 v[116:119], v14, s[20:23], s38 offen offset:256 sc1
    v_mfma_f32_16x16x32_bf16 a[96:99], v[72:75], a[192:195], a[96:99]
    buffer_store_dwordx4 v[124:127], v14, s[20:23], s38 offen offset:2304 sc1
    v_smfmac_f32_16x16x64_bf16 v[232:235], v[216:219], v[72:79], v15
    s_nop 7
    v_add_f32 v214, v232, v233
    v_rcp_f32 v215, v214
    v_cmp_nle_f32 s[46:47], v214, s40
    v_accvgpr_read_b32 v244, a96
    v_accvgpr_read_b32 v245, a97
    v_mov_b32_dpp v215, v215 row_shl:4 row_mask:0x2 bank_mask:0xf
    v_accvgpr_read_b32 v246, a98
    v_accvgpr_read_b32 v247, a99
    v_mov_b32_dpp v215, v215 row_shl:8 row_mask:0x4 bank_mask:0xf
    v_accvgpr_read_b32 v248, a100
    v_accvgpr_read_b32 v249, a101
    v_mov_b32_dpp v215, v215 row_shl:12 row_mask:0x8 bank_mask:0xf
    v_accvgpr_read_b32 v250, a102
    v_accvgpr_read_b32 v251, a103
    v_mov_b32_dpp v6, v215 row_newbcast:0 row_mask:0xf bank_mask:0xf
    v_mov_b32_dpp v7, v215 row_newbcast:1 row_mask:0xf bank_mask:0xf
    v_mov_b32_dpp v8, v215 row_newbcast:2 row_mask:0xf bank_mask:0xf
    v_mov_b32_dpp v9, v215 row_newbcast:3 row_mask:0xf bank_mask:0xf
    s_or_b64 s[44:45], s[44:45], s[46:47]
    v_pk_mul_f32 v[244:245], v[244:245], v[6:7]
    v_pk_mul_f32 v[246:247], v[246:247], v[8:9]
    v_pk_mul_f32 v[248:249], v[248:249], v[6:7]
    v_pk_mul_f32 v[250:251], v[250:251], v[8:9]
    v_cvt_pk_bf16_f32 v236, v244, v245
    v_cvt_pk_bf16_f32 v237, v246, v247
    v_cvt_pk_bf16_f32 v238, v248, v249
    v_cvt_pk_bf16_f32 v239, v250, v251
    ds_write_b64 v208, v[236:237] offset:4096
    ds_write_b64 v209, v[238:239] offset:4608
    v_accvgpr_read_b32 v72, a104
    v_accvgpr_read_b32 v73, a105
    v_accvgpr_read_b32 v74, a106
    v_accvgpr_read_b32 v75, a107
    v_accvgpr_read_b32 v76, a108
    v_accvgpr_read_b32 v77, a109
    v_accvgpr_read_b32 v78, a110
    v_accvgpr_read_b32 v79, a111
    v_pk_mul_f32 v[72:73], v[72:73], v[6:7]
    v_pk_mul_f32 v[74:75], v[74:75], v[8:9]
    v_pk_mul_f32 v[76:77], v[76:77], v[6:7]
    v_pk_mul_f32 v[78:79], v[78:79], v[8:9]
    v_cvt_pk_bf16_f32 v240, v72, v73
    v_cvt_pk_bf16_f32 v241, v74, v75
    v_cvt_pk_bf16_f32 v242, v76, v77
    v_cvt_pk_bf16_f32 v243, v78, v79
    ds_write_b64 v210, v[240:241] offset:5120
    ds_write_b64 v211, v[242:243] offset:5632
    v_accvgpr_read_b32 v244, a112
    v_accvgpr_read_b32 v245, a113
    v_accvgpr_read_b32 v246, a114
    v_accvgpr_read_b32 v247, a115
    v_accvgpr_read_b32 v248, a116
    v_accvgpr_read_b32 v249, a117
    v_accvgpr_read_b32 v250, a118
    v_accvgpr_read_b32 v251, a119
    v_pk_mul_f32 v[244:245], v[244:245], v[6:7]
    v_pk_mul_f32 v[246:247], v[246:247], v[8:9]
    v_pk_mul_f32 v[248:249], v[248:249], v[6:7]
    v_pk_mul_f32 v[250:251], v[250:251], v[8:9]
    v_cvt_pk_bf16_f32 v236, v244, v245
    v_cvt_pk_bf16_f32 v237, v246, v247
    v_cvt_pk_bf16_f32 v238, v248, v249
    v_cvt_pk_bf16_f32 v239, v250, v251
    ds_write_b64 v208, v[236:237] offset:6144
    ds_write_b64 v209, v[238:239] offset:6656
    v_accvgpr_read_b32 v72, a120
    v_accvgpr_read_b32 v73, a121
    v_accvgpr_read_b32 v74, a122
    v_accvgpr_read_b32 v75, a123
    v_accvgpr_read_b32 v76, a124
    v_accvgpr_read_b32 v77, a125
    v_accvgpr_read_b32 v78, a126
    v_accvgpr_read_b32 v79, a127
    v_pk_mul_f32 v[72:73], v[72:73], v[6:7]
    v_pk_mul_f32 v[74:75], v[74:75], v[8:9]
    v_pk_mul_f32 v[76:77], v[76:77], v[6:7]
    v_pk_mul_f32 v[78:79], v[78:79], v[8:9]
    v_cvt_pk_bf16_f32 v240, v72, v73
    v_cvt_pk_bf16_f32 v241, v74, v75
    v_cvt_pk_bf16_f32 v242, v76, v77
    v_cvt_pk_bf16_f32 v243, v78, v79
    ds_write_b64 v210, v[240:241] offset:7168
    ds_write_b64 v211, v[242:243] offset:7680
    ds_read_b64_tr_b16 v[128:129], v212 offset:4096
    ds_read_b64_tr_b16 v[130:131], v213 offset:4224
    ds_read_b64_tr_b16 v[132:133], v252 offset:4352
    ds_read_b64_tr_b16 v[134:135], v253 offset:4480
    ds_read_b64_tr_b16 v[136:137], v252 offset:4096
    ds_read_b64_tr_b16 v[138:139], v253 offset:4224
    ds_read_b64_tr_b16 v[140:141], v212 offset:4352
    ds_read_b64_tr_b16 v[142:143], v213 offset:4480
    s_waitcnt lgkmcnt(0)
    s_mov_b64 vcc, s[94:95]
    v_cndmask_b32_dpp v72, v132, v128, vcc quad_perm:[1,0,3,2] row_mask:0xf bank_mask:0xf
    v_cndmask_b32_dpp v73, v133, v129, vcc quad_perm:[1,0,3,2] row_mask:0xf bank_mask:0xf
    v_cndmask_b32_dpp v74, v134, v130, vcc quad_perm:[1,0,3,2] row_mask:0xf bank_mask:0xf
    v_cndmask_b32_dpp v75, v135, v131, vcc quad_perm:[1,0,3,2] row_mask:0xf bank_mask:0xf
    v_cndmask_b32_dpp v76, v140, v136, vcc quad_perm:[1,0,3,2] row_mask:0xf bank_mask:0xf
    v_cndmask_b32_dpp v77, v141, v137, vcc quad_perm:[1,0,3,2] row_mask:0xf bank_mask:0xf
    v_cndmask_b32_dpp v78, v142, v138, vcc quad_perm:[1,0,3,2] row_mask:0xf bank_mask:0xf
    v_cndmask_b32_dpp v79, v143, v139, vcc quad_perm:[1,0,3,2] row_mask:0xf bank_mask:0xf
    s_not_b64 vcc, vcc
    v_cndmask_b32_dpp v132, v128, v132, vcc quad_perm:[1,0,3,2] row_mask:0xf bank_mask:0xf
    v_cndmask_b32_dpp v133, v129, v133, vcc quad_perm:[1,0,3,2] row_mask:0xf bank_mask:0xf
    v_cndmask_b32_dpp v134, v130, v134, vcc quad_perm:[1,0,3,2] row_mask:0xf bank_mask:0xf
    v_cndmask_b32_dpp v135, v131, v135, vcc quad_perm:[1,0,3,2] row_mask:0xf bank_mask:0xf
    v_cndmask_b32_dpp v140, v136, v140, vcc quad_perm:[1,0,3,2] row_mask:0xf bank_mask:0xf
    v_cndmask_b32_dpp v141, v137, v141, vcc quad_perm:[1,0,3,2] row_mask:0xf bank_mask:0xf
    v_cndmask_b32_dpp v142, v138, v142, vcc quad_perm:[1,0,3,2] row_mask:0xf bank_mask:0xf
    v_cndmask_b32_dpp v143, v139, v143, vcc quad_perm:[1,0,3,2] row_mask:0xf bank_mask:0xf
    buffer_store_dwordx4 v[72:75], v14, s[20:23], s39 offen offset:0 sc1
    buffer_store_dwordx4 v[76:79], v14, s[20:23], s39 offen offset:2048 sc1
    buffer_store_dwordx4 v[132:135], v14, s[20:23], s39 offen offset:256 sc1
    buffer_store_dwordx4 v[140:143], v14, s[20:23], s39 offen offset:2304 sc1
    s_cmp_lg_u64 s[44:45], 0
    s_cselect_b32 s50, 1, 0
    v_mov_b32 v11, s50
    v_lshlrev_b32 v10, 2, v1
    v_add_u32 v10, s42, v10
    ds_write_b32 v10, v11
    s_cmp_lg_u32 s32, 0
    s_cbranch_scc1 L_end
    v_and_b32 v10, 3, v1
    v_lshlrev_b32 v10, 14, v10
    v_add_u32 v10, 0x18000, v10
    s_waitcnt lgkmcnt(0)
    s_barrier
    ds_read_b32 v11, v10
    s_waitcnt lgkmcnt(0)
    v_cmp_ne_u32 vcc, 0, v11
    s_nop 1
    s_cbranch_vccz L_end
L_fallback:
    s_waitcnt vmcnt(0)
    v_and_b32 v10, 15, v1
    v_lshlrev_b32 v10, 8, v10
    v_lshrrev_b32 v11, 4, v1
    v_lshl_add_u32 v10, v11, 4, v10
    v_mov_b32 v2, 0xff800000
    v_mov_b32 v3, 0xff800000
    v_mov_b32 v4, 0xff800000
    v_mov_b32 v5, 0xff800000
    s_mov_b32 s50, 0
L_maxloop:
    buffer_load_dwordx4 v[48:51], v10, s[12:15], s50 offen offset:0
    buffer_load_dwordx4 v[52:55], v10, s[12:15], s50 offen offset:64
    buffer_load_dwordx4 v[56:59], v10, s[12:15], s50 offen offset:128
    buffer_load_dwordx4 v[60:63], v10, s[12:15], s50 offen offset:192
    s_waitcnt vmcnt(0)
    v_mfma_f32_16x16x32_bf16 v[80:83], v[48:51], v[144:147], 0
    v_mfma_f32_16x16x32_bf16 v[84:87], v[48:51], v[160:163], 0
    v_mfma_f32_16x16x32_bf16 v[88:91], v[48:51], v[176:179], 0
    v_mfma_f32_16x16x32_bf16 v[92:95], v[48:51], v[192:195], 0
    v_mfma_f32_16x16x32_bf16 v[80:83], v[52:55], v[148:151], v[80:83]
    v_mfma_f32_16x16x32_bf16 v[84:87], v[52:55], v[164:167], v[84:87]
    v_mfma_f32_16x16x32_bf16 v[88:91], v[52:55], v[180:183], v[88:91]
    v_mfma_f32_16x16x32_bf16 v[92:95], v[52:55], v[196:199], v[92:95]
    v_mfma_f32_16x16x32_bf16 v[80:83], v[56:59], v[152:155], v[80:83]
    v_mfma_f32_16x16x32_bf16 v[84:87], v[56:59], v[168:171], v[84:87]
    v_mfma_f32_16x16x32_bf16 v[88:91], v[56:59], v[184:187], v[88:91]
    v_mfma_f32_16x16x32_bf16 v[92:95], v[56:59], v[200:203], v[92:95]
    v_mfma_f32_16x16x32_bf16 v[80:83], v[60:63], v[156:159], v[80:83]
    v_mfma_f32_16x16x32_bf16 v[84:87], v[60:63], v[172:175], v[84:87]
    v_mfma_f32_16x16x32_bf16 v[88:91], v[60:63], v[188:191], v[88:91]
    v_mfma_f32_16x16x32_bf16 v[92:95], v[60:63], v[204:207], v[92:95]
    s_nop 7
    v_max3_f32 v2, v2, v80, v81
    v_max3_f32 v2, v2, v82, v83
    v_max3_f32 v3, v3, v84, v85
    v_max3_f32 v3, v3, v86, v87
    v_max3_f32 v4, v4, v88, v89
    v_max3_f32 v4, v4, v90, v91
    v_max3_f32 v5, v5, v92, v93
    v_max3_f32 v5, v5, v94, v95
    s_add_u32 s50, s50, 4096
    s_cmp_lt_u32 s50, 0x80000
    s_cbranch_scc1 L_maxloop
    v_mov_b32 v6, v2
    v_mov_b32 v7, v3
    v_mov_b32 v8, v4
    v_mov_b32 v9, v5
    v_permlane32_swap_b32 v2, v6
    v_permlane32_swap_b32 v3, v7
    v_permlane32_swap_b32 v4, v8
    v_permlane32_swap_b32 v5, v9
    v_max_f32 v2, v2, v6
    v_max_f32 v3, v3, v7
    v_max_f32 v4, v4, v8
    v_max_f32 v5, v5, v9
    v_mov_b32 v6, v2
    v_mov_b32 v7, v3
    v_mov_b32 v8, v4
    v_mov_b32 v9, v5
    v_permlane16_swap_b32 v2, v6
    v_permlane16_swap_b32 v3, v7
    v_permlane16_swap_b32 v4, v8
    v_permlane16_swap_b32 v5, v9
    v_max_f32 v2, v2, v6
    v_max_f32 v3, v3, v7
    v_max_f32 v4, v4, v8
    v_max_f32 v5, v5, v9
    v_mul_f32 v32, -1.0, v2
    v_mul_f32 v33, -1.0, v2
    v_mul_f32 v34, -1.0, v2
    v_mul_f32 v35, -1.0, v2
    v_mul_f32 v36, -1.0, v3
    v_mul_f32 v37, -1.0, v3
    v_mul_f32 v38, -1.0, v3
    v_mul_f32 v39, -1.0, v3
    v_mul_f32 v40, -1.0, v4
    v_mul_f32 v41, -1.0, v4
    v_mul_f32 v42, -1.0, v4
    v_mul_f32 v43, -1.0, v4
    v_mul_f32 v44, -1.0, v5
    v_mul_f32 v45, -1.0, v5
    v_mul_f32 v46, -1.0, v5
    v_mul_f32 v47, -1.0, v5
    s_mov_b32 s32, 1
    s_mov_b64 s[48:49], 0
    s_barrier
    s_branch L_restart
L_end:
    s_endpgm
.section .rodata,"a"
.p2align 6
.amdhsa_kernel standalone__gqa_softmax__prompt_kernel
  .amdhsa_next_free_vgpr 512
  .amdhsa_next_free_sgpr 102
  .amdhsa_accum_offset 256
  .amdhsa_group_segment_fixed_size 0
  .amdhsa_kernarg_size 48
  .amdhsa_user_sgpr_count 2
  .amdhsa_user_sgpr_kernarg_segment_ptr 1
  .amdhsa_system_sgpr_workgroup_id_x 1
.end_amdhsa_kernel
```
